```python
import torch

def _softmax(x, axis=-1):
    return torch.softmax(x, dim=axis)
def _gelu(x):
    return torch.nn.functional.gelu(x, approximate="tanh")
def _silu(x):
    return torch.nn.functional.silu(x)
def _sigmoid(x):
    return torch.sigmoid(x)
def _layernorm(x, axis=-1, eps=1e-5):
    m = x.mean(dim=axis, keepdim=True)
    v = x.var(dim=axis, keepdim=True, unbiased=False)
    return (x - m) / torch.sqrt(v + eps)
def _scatter_add(tgt, idx, src, axis=0):
    return tgt.clone().index_add_(axis, idx, src)
def _segment_sum(src, seg, n):
    out = torch.zeros((n,) + src.shape[1:], dtype=src.dtype)
    return out.index_add_(0, seg, src)
def _pad(x, pw):
    flat = tuple(v for pair in reversed(pw) for v in pair)
    return torch.nn.functional.pad(x, flat)

kernel_name = 'gated_mix__mha_block_cached__glu_gated_swiglu__decode'

def setup_inputs():

    _w = (lambda a: (lambda t: t.to(torch.bfloat16) if t.is_floating_point() else t)(torch.as_tensor(a)))
    def _A_setup():
        B, Sq, D = 4, 1, 512
        H, Sk, Dh = 32, 8192, 128
        return {
            "x": _w((lambda *s: torch.randn(*s, dtype=torch.bfloat16) * 0.05)(B, Sq, D)),
            "k_cache": _w((lambda *s: torch.randn(*s, dtype=torch.bfloat16) * 6.4)(B, H, Sk, Dh)),
            "v_cache": _w((lambda *s: torch.randn(*s, dtype=torch.bfloat16) * 0.2)(B, H, Sk, Dh)),
            "wq": _w((lambda *s: torch.randn(*s, dtype=torch.bfloat16) * 6.4)(D, H * Dh) * (D ** -0.5)),
            "wo": _w((lambda *s: torch.randn(*s, dtype=torch.bfloat16) * 0.2)(H * Dh, D) * ((H * Dh) ** -0.5)),
        }
    _A_in = _A_setup()

    def _B_setup():
        B, S, D, F = 4, 1, 512, 1792
        return {
            "x": _w((lambda *s: torch.randn(*s, dtype=torch.bfloat16) * 0.05)(B, S, D)),
            "w1": _w((lambda *s: torch.randn(*s, dtype=torch.bfloat16) * 0.8)(D, F) * (2.0 / D) ** 0.5),
            "w3": _w((lambda *s: torch.randn(*s, dtype=torch.bfloat16) * 0.8)(D, F) * (2.0 / D) ** 0.5),
            "w2": _w((lambda *s: torch.randn(*s, dtype=torch.bfloat16) * 0.8)(F, D) * (2.0 / F) ** 0.5),
        }
    _B_in = _B_setup()

    return {
        "A_x": _A_in["x"],
        "A_k_cache": _A_in["k_cache"],
        "A_v_cache": _A_in["v_cache"],
        "A_wq": _A_in["wq"],
        "A_wo": _A_in["wo"],
        "B_x": _B_in["x"],
        "B_w1": _B_in["w1"],
        "B_w3": _B_in["w3"],
        "B_w2": _B_in["w2"],
        "gate_w": _w((lambda *s: torch.randn(*s, dtype=torch.bfloat16) * 0.05)(512) * 16.0),
    }

def reference(A_x, A_k_cache, A_v_cache, A_wq, A_wo, B_x, B_w1, B_w3, B_w2, gate_w):
    def _A_ref(x, k_cache, v_cache, wq, wo):
        B, Sq, D = x.shape
        H, Dh = 32, 128
        q = (lambda x, *d: x.permute(*d))((x @ wq).reshape(B, Sq, H, Dh), 0, 2, 1, 3)
        scores = torch.einsum("bhqd,bhkd->bhqk", q, k_cache) * (Dh ** -0.5)
        p = _softmax(scores, axis=-1)
        o = torch.einsum("bhqk,bhkd->bhqd", p, v_cache)
        return (lambda x, *d: x.permute(*d))(o, 0, 2, 1, 3).reshape(B, Sq, H * Dh) @ wo

    def _B_ref(x, w1, w3, w2):
        gate = torch.einsum("bsd,df->bsf", x, w1)
        up = torch.einsum("bsd,df->bsf", x, w3)
        h = _silu(gate) * up
        out = torch.einsum("bsf,fd->bsd", h, w2)
        return out

    x = A_x
    g = _sigmoid((x * gate_w).sum(-1, keepdims=True))
    a = _A_ref(x, A_k_cache, A_v_cache, A_wq, A_wo)
    b = _B_ref(x, B_w1, B_w3, B_w2)
    return g * a + (1 - g) * b
```

```asm
; @launch grid=(256,1,1) block=(1024,1,1) lds=82432
.amdgcn_target "amdgcn-amd-amdhsa--gfx950"
.text
.globl gated_mix__mha_block_cached__glu_gated_swiglu__decode_kernel
.p2align 8
.type gated_mix__mha_block_cached__glu_gated_swiglu__decode_kernel,@function
gated_mix__mha_block_cached__glu_gated_swiglu__decode_kernel:
    s_cmp_ge_u32 s2, 256
    s_cbranch_scc1 L_end
    s_load_dwordx16 s[4:19], s[0:1], 0
    s_load_dwordx8 s[20:27], s[0:1], 64
    s_load_dwordx2 s[28:29], s[0:1], 96
    v_lshrrev_b32 v1, 6, v0
    v_and_b32 v7, 63, v0
    v_readfirstlane_b32 s3, v1
    v_lshlrev_b32 v1, 4, v7
    v_lshrrev_b32 v5, 4, v7
    v_and_b32 v6, 15, v7
    s_lshr_b32 s83, s2, 3
    s_and_b32 s82, s2, 7
    s_and_b32 s78, s83, 1
    s_lshr_b32 s77, s83, 1
    s_and_b32 s77, s77, 3
    s_lshl_b32 s77, s77, 3
    s_add_u32 s77, s77, s82
    s_lshr_b32 s76, s83, 3
    s_lshl_b32 s93, s77, 1
    s_add_u32 s93, s93, s78
    s_lshl_b32 s85, s76, 6
    s_add_u32 s85, s85, s93
    s_mov_b32 s86, s85
    s_lshl_b32 s86, s86, 20
    s_lshl_b32 s81, s3, 12
    s_mov_b32 s35, 0x20000
    s_mov_b32 s39, 0x20000
    s_mov_b32 s43, 0x20000
    s_mov_b32 s51, 0x20000
    s_mov_b32 s34, 0x100000
    s_mov_b32 s38, 0x100000
    s_mov_b32 s42, 0x400000
    s_mov_b32 s50, 0x1000
    v_lshlrev_b32 v8, 16, v5
    v_lshl_add_u32 v8, v6, 4, v8
    s_lshl_b32 s88, s3, 18
    s_lshl_b32 s89, s77, 8
    s_add_u32 s88, s88, s89
    v_add_u32 v8, s88, v8
    v_add_u32 v9, 0x8000, v8
    s_lshl_b32 s89, s76, 10
    s_lshl_b32 s90, s3, 6
    s_add_u32 s90, s90, s89
    v_lshlrev_b32 v10, 4, v5
    s_movk_i32 s94, 0x2000
    s_movk_i32 s95, 0x4000
    s_movk_i32 s96, 0x6000
    s_waitcnt lgkmcnt(0)
    s_mov_b32 s48, s4
    s_mov_b32 s49, s5
    s_mov_b32 s40, s10
    s_mov_b32 s41, s11
    s_add_u32 s32, s6, s86
    s_addc_u32 s33, s7, 0
    s_add_u32 s36, s8, s86
    s_addc_u32 s37, s9, 0
    s_mov_b32 s64, s26
    s_mov_b32 s65, s27
    s_mov_b32 s68, s24
    s_mov_b32 s69, s25
    s_setprio 3
    s_mov_b32 s60, s28
    s_mov_b32 s61, s29
    s_mov_b32 s62, 0x200000
    s_mov_b32 s63, 0x20000
    s_lshl_b32 s100, s76, 19
    s_lshl_b32 s101, s93, 7
    s_add_u32 s100, s100, s101
    s_cmp_lg_u32 s3, 0
    s_cbranch_scc1 L_noclrA
    v_lshrrev_b32 v14, 3, v7
    v_lshlrev_b32 v14, 13, v14
    v_and_b32 v15, 7, v7
    v_lshl_add_u32 v14, v15, 4, v14
    v_mov_b32 v112, -1
    v_mov_b32 v113, -1
    v_mov_b32 v114, -1
    v_mov_b32 v115, -1
    s_mov_b32 s101, s100
    buffer_store_dwordx4 v[112:115], v14, s[60:63], s101 offen sc1
    s_add_u32 s101, s101, 0x10000
    buffer_store_dwordx4 v[112:115], v14, s[60:63], s101 offen sc1
    s_add_u32 s101, s101, 0x10000
    buffer_store_dwordx4 v[112:115], v14, s[60:63], s101 offen sc1
    s_add_u32 s101, s101, 0x10000
    buffer_store_dwordx4 v[112:115], v14, s[60:63], s101 offen sc1
    s_add_u32 s101, s101, 0x10000
    buffer_store_dwordx4 v[112:115], v14, s[60:63], s101 offen sc1
    s_add_u32 s101, s101, 0x10000
    buffer_store_dwordx4 v[112:115], v14, s[60:63], s101 offen sc1
    s_add_u32 s101, s101, 0x10000
    buffer_store_dwordx4 v[112:115], v14, s[60:63], s101 offen sc1
    s_add_u32 s101, s101, 0x10000
    buffer_store_dwordx4 v[112:115], v14, s[60:63], s101 offen sc1
    s_add_u32 s101, s101, 0x10000
L_noclrA:
    buffer_load_dwordx4 v[120:123], v10, s[48:51], s90 offen
    buffer_load_dwordx4 v[48:51], v8, s[40:43], 0 offen
    buffer_load_dwordx4 v[52:55], v8, s[40:43], s94 offen
    buffer_load_dwordx4 v[16:19], v1, s[32:35], s81 offen offset:0 sc1 nt
    buffer_load_dwordx4 v[56:59], v8, s[40:43], s95 offen
    buffer_load_dwordx4 v[60:63], v8, s[40:43], s96 offen
    buffer_load_dwordx4 v[20:23], v1, s[32:35], s81 offen offset:1024 sc1 nt
    buffer_load_dwordx4 v[64:67], v9, s[40:43], 0 offen
    buffer_load_dwordx4 v[68:71], v9, s[40:43], s94 offen
    buffer_load_dwordx4 v[24:27], v1, s[32:35], s81 offen offset:2048 sc1 nt
    buffer_load_dwordx4 v[72:75], v9, s[40:43], s95 offen
    buffer_load_dwordx4 v[76:79], v9, s[40:43], s96 offen
    buffer_load_dwordx4 v[28:31], v1, s[32:35], s81 offen offset:3072 sc1 nt
    s_mov_b32 s44, s12
    s_mov_b32 s45, s13
    s_mov_b32 s46, 0x400000
    s_mov_b32 s47, 0x20000
    s_mov_b32 s66, 0x100
    s_mov_b32 s67, 0x20000
    s_mov_b32 s70, 0x1000
    s_mov_b32 s71, 0x20000
    s_mov_b32 s72, s22
    s_mov_b32 s73, s23
    s_mov_b32 s74, 0x400
    s_mov_b32 s75, 0x20000
    s_mov_b32 s86, 0xffff0000
    s_mov_b32 s87, 0xffff
    s_waitcnt vmcnt(11)
    s_cmp_lg_u32 s3, 0
    s_cbranch_scc1 L_nosigA
    v_mov_b32 v118, 1
    s_mov_b64 exec, 1
    buffer_store_byte v118, off, s[64:67], s85 sc1
    s_mov_b64 exec, -1
L_nosigA:
    v_and_b32 v124, s87, v120
    v_lshlrev_b32 v125, 16, v120
    v_dot2_f32_bf16 v104, v48, v124, 0
    v_dot2_f32_bf16 v105, v48, v125, 0
    v_dot2_f32_bf16 v106, v49, v124, 0
    v_dot2_f32_bf16 v107, v49, v125, 0
    v_dot2_f32_bf16 v108, v50, v124, 0
    v_dot2_f32_bf16 v109, v50, v125, 0
    v_dot2_f32_bf16 v110, v51, v124, 0
    v_dot2_f32_bf16 v111, v51, v125, 0
    s_waitcnt vmcnt(10)
    v_lshrrev_b32 v126, 16, v120
    v_and_b32 v127, s86, v120
    v_dot2_f32_bf16 v104, v52, v126, v104
    v_dot2_f32_bf16 v105, v52, v127, v105
    v_dot2_f32_bf16 v106, v53, v126, v106
    v_dot2_f32_bf16 v107, v53, v127, v107
    v_dot2_f32_bf16 v108, v54, v126, v108
    v_dot2_f32_bf16 v109, v54, v127, v109
    v_dot2_f32_bf16 v110, v55, v126, v110
    v_dot2_f32_bf16 v111, v55, v127, v111
    s_waitcnt vmcnt(8)
    v_and_b32 v124, s87, v121
    v_lshlrev_b32 v125, 16, v121
    v_dot2_f32_bf16 v104, v56, v124, v104
    v_dot2_f32_bf16 v105, v56, v125, v105
    v_dot2_f32_bf16 v106, v57, v124, v106
    v_dot2_f32_bf16 v107, v57, v125, v107
    v_dot2_f32_bf16 v108, v58, v124, v108
    v_dot2_f32_bf16 v109, v58, v125, v109
    v_dot2_f32_bf16 v110, v59, v124, v110
    v_dot2_f32_bf16 v111, v59, v125, v111
    s_waitcnt vmcnt(7)
    v_lshrrev_b32 v126, 16, v121
    v_and_b32 v127, s86, v121
    v_dot2_f32_bf16 v104, v60, v126, v104
    v_dot2_f32_bf16 v105, v60, v127, v105
    v_dot2_f32_bf16 v106, v61, v126, v106
    v_dot2_f32_bf16 v107, v61, v127, v107
    v_dot2_f32_bf16 v108, v62, v126, v108
    v_dot2_f32_bf16 v109, v62, v127, v109
    v_dot2_f32_bf16 v110, v63, v126, v110
    v_dot2_f32_bf16 v111, v63, v127, v111
    s_waitcnt vmcnt(5)
    v_and_b32 v124, s87, v122
    v_lshlrev_b32 v125, 16, v122
    v_dot2_f32_bf16 v104, v64, v124, v104
    v_dot2_f32_bf16 v105, v64, v125, v105
    v_dot2_f32_bf16 v106, v65, v124, v106
    v_dot2_f32_bf16 v107, v65, v125, v107
    v_dot2_f32_bf16 v108, v66, v124, v108
    v_dot2_f32_bf16 v109, v66, v125, v109
    v_dot2_f32_bf16 v110, v67, v124, v110
    v_dot2_f32_bf16 v111, v67, v125, v111
    s_waitcnt vmcnt(4)
    v_lshrrev_b32 v126, 16, v122
    v_and_b32 v127, s86, v122
    v_dot2_f32_bf16 v104, v68, v126, v104
    v_dot2_f32_bf16 v105, v68, v127, v105
    v_dot2_f32_bf16 v106, v69, v126, v106
    v_dot2_f32_bf16 v107, v69, v127, v107
    v_dot2_f32_bf16 v108, v70, v126, v108
    v_dot2_f32_bf16 v109, v70, v127, v109
    v_dot2_f32_bf16 v110, v71, v126, v110
    v_dot2_f32_bf16 v111, v71, v127, v111
    s_waitcnt vmcnt(2)
    v_and_b32 v124, s87, v123
    v_lshlrev_b32 v125, 16, v123
    v_dot2_f32_bf16 v104, v72, v124, v104
    v_dot2_f32_bf16 v105, v72, v125, v105
    v_dot2_f32_bf16 v106, v73, v124, v106
    v_dot2_f32_bf16 v107, v73, v125, v107
    v_dot2_f32_bf16 v108, v74, v124, v108
    v_dot2_f32_bf16 v109, v74, v125, v109
    v_dot2_f32_bf16 v110, v75, v124, v110
    v_dot2_f32_bf16 v111, v75, v125, v111
    s_waitcnt vmcnt(1)
    v_lshrrev_b32 v126, 16, v123
    v_and_b32 v127, s86, v123
    v_dot2_f32_bf16 v104, v76, v126, v104
    v_dot2_f32_bf16 v105, v76, v127, v105
    v_dot2_f32_bf16 v106, v77, v126, v106
    v_dot2_f32_bf16 v107, v77, v127, v107
    v_dot2_f32_bf16 v108, v78, v126, v108
    v_dot2_f32_bf16 v109, v78, v127, v109
    v_dot2_f32_bf16 v110, v79, v126, v110
    v_dot2_f32_bf16 v111, v79, v127, v111
    v_lshlrev_b32 v8, 5, v6
    v_lshl_add_u32 v8, v5, 3, v8
    s_lshl_b32 s97, s3, 9
    v_add_u32 v8, s97, v8
    v_lshlrev_b32 v9, 11, v5
    v_lshl_add_u32 v9, v6, 5, v9
    v_permlane32_swap_b32 v104, v108
    v_permlane32_swap_b32 v105, v109
    v_permlane32_swap_b32 v106, v110
    v_permlane32_swap_b32 v107, v111
    v_add_f32 v104, v104, v108
    v_add_f32 v105, v105, v109
    v_add_f32 v106, v106, v110
    v_add_f32 v107, v107, v111
    s_nop 0
    v_permlane16_swap_b32 v104, v106
    v_permlane16_swap_b32 v105, v107
    v_add_f32 v104, v104, v106
    v_add_f32 v105, v105, v107
    ds_write_b64 v8, v[104:105] offset:0
    v_mov_b32 v10, 0xc0000
    v_mov_b32 v11, 0
    ds_write_b32 v11, v10 offset:12416
    buffer_load_dwordx4 v[32:35], v1, s[36:39], s81 offen offset:0 sc1 nt
    buffer_load_dwordx4 v[36:39], v1, s[36:39], s81 offen offset:1024 sc1 nt
    buffer_load_dwordx4 v[40:43], v1, s[36:39], s81 offen offset:2048 sc1 nt
    buffer_load_dwordx4 v[44:47], v1, s[36:39], s81 offen offset:3072 sc1 nt
    s_add_u32 s80, s81, 0x10000
    buffer_load_dwordx4 v[80:83], v1, s[32:35], s80 offen offset:0 sc1 nt
    buffer_load_dwordx4 v[84:87], v1, s[32:35], s80 offen offset:1024 sc1 nt
    buffer_load_dwordx4 v[88:91], v1, s[32:35], s80 offen offset:2048 sc1 nt
    buffer_load_dwordx4 v[92:95], v1, s[32:35], s80 offen offset:3072 sc1 nt
    buffer_load_dwordx4 v[64:67], v1, s[36:39], s80 offen offset:0 sc1 nt
    buffer_load_dwordx4 v[68:71], v1, s[36:39], s80 offen offset:1024 sc1 nt
    buffer_load_dwordx4 v[72:75], v1, s[36:39], s80 offen offset:2048 sc1 nt
    buffer_load_dwordx4 v[76:79], v1, s[36:39], s80 offen offset:3072 sc1 nt
    s_waitcnt lgkmcnt(0)
    s_barrier
    ds_read_b128 v[48:51], v9 offset:0
    ds_read_b128 v[52:55], v9 offset:16
    ds_read_b128 v[56:59], v9 offset:512
    ds_read_b128 v[60:63], v9 offset:528
    ds_read_b128 v[96:99], v9 offset:1024
    ds_read_b128 v[100:103], v9 offset:1040
    ds_read_b128 v[104:107], v9 offset:1536
    ds_read_b128 v[108:111], v9 offset:1552
    v_mov_b32 v116, 0xff800000
    v_mov_b32 v117, 0
    s_mov_b32 s88, 0x3e0293ee
    s_mov_b32 s89, 0xbe0293ee
    s_waitcnt lgkmcnt(4)
    v_pk_add_f32 v[48:49], v[48:49], v[56:57]
    v_pk_add_f32 v[50:51], v[50:51], v[58:59]
    v_pk_add_f32 v[52:53], v[52:53], v[60:61]
    v_pk_add_f32 v[54:55], v[54:55], v[62:63]
    s_waitcnt lgkmcnt(0)
    v_pk_add_f32 v[96:97], v[96:97], v[104:105]
    v_pk_add_f32 v[98:99], v[98:99], v[106:107]
    v_pk_add_f32 v[100:101], v[100:101], v[108:109]
    v_pk_add_f32 v[102:103], v[102:103], v[110:111]
    v_pk_add_f32 v[8:9], v[48:49], v[96:97]
    v_pk_add_f32 v[10:11], v[50:51], v[98:99]
    v_pk_add_f32 v[12:13], v[52:53], v[100:101]
    v_pk_add_f32 v[14:15], v[54:55], v[102:103]
    v_mov_b32 v104, 0
    v_mov_b32 v105, 0
    v_mov_b32 v106, 0
    v_mov_b32 v107, 0
    v_mov_b32 v108, 0
    v_mov_b32 v109, 0
    v_mov_b32 v110, 0
    v_mov_b32 v111, 0
    v_permlane32_swap_b32 v8, v12
    v_permlane32_swap_b32 v9, v13
    v_permlane32_swap_b32 v10, v14
    v_permlane32_swap_b32 v11, v15
    v_add_f32 v8, v8, v12
    v_add_f32 v9, v9, v13
    v_add_f32 v10, v10, v14
    v_add_f32 v11, v11, v15
    s_nop 0
    v_permlane16_swap_b32 v8, v10
    v_permlane16_swap_b32 v9, v11
    v_add_f32 v8, v8, v10
    v_add_f32 v9, v9, v11
    v_cvt_pk_bf16_f32 v112, v8, v9
    v_mov_b32 v113, v112
    s_nop 1
    v_permlane16_swap_b32 v112, v113
    v_mov_b32 v114, v112
    v_mov_b32 v115, v113
    s_nop 0
    v_permlane32_swap_b32 v112, v114
    v_permlane32_swap_b32 v113, v115
    s_and_b32 s84, s83, 7
    s_cmp_lt_u32 s84, 7
    s_cselect_b32 s92, 1.0, 0
    s_min_u32 s84, s84, 6
    s_mul_i32 s79, s82, 7
    s_add_u32 s79, s79, s84
    s_and_b32 s91, s3, 7
    v_lshrrev_b32 v12, 2, v7
    v_and_b32 v13, 3, v7
    v_mul_u32_u24 v11, 14336, v12
    v_lshl_add_u32 v11, v13, 4, v11
    s_mul_i32 s97, s91, 229376
    s_lshl_b32 s98, s79, 6
    s_add_u32 s97, s97, s98
    v_add_u32 v11, s97, v11
    s_lshl_b32 s97, s91, 7
    s_lshl_b32 s98, s76, 10
    s_add_u32 s97, s97, s98
    v_lshlrev_b32 v12, 3, v12
    s_lshl_b32 s99, s79, 15
    s_lshl_b32 s98, s3, 11
    s_add_u32 s99, s99, s98
    s_mov_b32 s55, 0x20000
    s_mov_b32 s59, 0x20000
    s_mov_b32 s54, 0x1c0000
    s_mov_b32 s58, 0x1c0000
    s_cmp_lt_u32 s3, 8
    s_cselect_b32 s52, s16, s18
    s_cselect_b32 s53, s17, s19
    s_mov_b32 s56, s20
    s_mov_b32 s57, s21
    s_movk_i32 s94, 3584
    s_movk_i32 s95, 7168
    s_movk_i32 s96, 10752
    v_mov_b32 v103, v11
    buffer_load_dwordx2 v[118:119], v12, s[48:51], s97 offen
    v_mov_b32 v7, 0x1000
    s_add_u32 s81, s81, 0x20000
    s_waitcnt vmcnt(22)
    v_dot2_f32_bf16 v120, v16, v112, 0
    v_dot2_f32_bf16 v120, v17, v113, v120
    v_dot2_f32_bf16 v120, v18, v114, v120
    v_dot2_f32_bf16 v120, v19, v115, v120
    buffer_load_dwordx4 v[16:19], v1, s[32:35], s81 offen offset:0 sc1 nt
    s_waitcnt vmcnt(20)
    v_dot2_f32_bf16 v121, v20, v112, 0
    v_dot2_f32_bf16 v121, v21, v113, v121
    v_dot2_f32_bf16 v121, v22, v114, v121
    v_dot2_f32_bf16 v121, v23, v115, v121
    buffer_load_dwordx4 v[20:23], v1, s[32:35], s81 offen offset:1024 sc1 nt
    s_waitcnt vmcnt(18)
    v_dot2_f32_bf16 v122, v24, v112, 0
    v_dot2_f32_bf16 v122, v25, v113, v122
    v_dot2_f32_bf16 v122, v26, v114, v122
    v_dot2_f32_bf16 v122, v27, v115, v122
    buffer_load_dwordx4 v[24:27], v1, s[32:35], s81 offen offset:2048 sc1 nt
    s_waitcnt vmcnt(16)
    v_dot2_f32_bf16 v123, v28, v112, 0
    v_dot2_f32_bf16 v123, v29, v113, v123
    v_dot2_f32_bf16 v123, v30, v114, v123
    v_dot2_f32_bf16 v123, v31, v115, v123
    buffer_load_dwordx4 v[28:31], v1, s[32:35], s81 offen offset:3072 sc1 nt
    v_add_f32_dpp v120, v120, v120 row_ror:8 row_mask:0xf bank_mask:0xf
    v_add_f32_dpp v121, v121, v121 row_ror:8 row_mask:0xf bank_mask:0xf
    v_add_f32_dpp v122, v122, v122 row_ror:8 row_mask:0xf bank_mask:0xf
    v_add_f32_dpp v123, v123, v123 row_ror:8 row_mask:0xf bank_mask:0xf
    v_add_f32_dpp v120, v120, v120 row_ror:4 row_mask:0xf bank_mask:0xf
    v_add_f32_dpp v121, v121, v121 row_ror:4 row_mask:0xf bank_mask:0xf
    v_add_f32_dpp v122, v122, v122 row_ror:4 row_mask:0xf bank_mask:0xf
    v_add_f32_dpp v123, v123, v123 row_ror:4 row_mask:0xf bank_mask:0xf
    v_add_f32_dpp v120, v120, v120 row_ror:2 row_mask:0xf bank_mask:0xf
    v_add_f32_dpp v121, v121, v121 row_ror:2 row_mask:0xf bank_mask:0xf
    v_add_f32_dpp v122, v122, v122 row_ror:2 row_mask:0xf bank_mask:0xf
    v_add_f32_dpp v123, v123, v123 row_ror:2 row_mask:0xf bank_mask:0xf
    v_add_f32_dpp v120, v120, v120 row_ror:1 row_mask:0xf bank_mask:0xf
    v_add_f32_dpp v121, v121, v121 row_ror:1 row_mask:0xf bank_mask:0xf
    v_add_f32_dpp v122, v122, v122 row_ror:1 row_mask:0xf bank_mask:0xf
    v_add_f32_dpp v123, v123, v123 row_ror:1 row_mask:0xf bank_mask:0xf
    v_max3_f32 v3, v120, v121, v116
    v_max3_f32 v3, v122, v123, v3
    v_sub_f32 v2, v116, v3
    v_mul_f32 v4, s89, v3
    v_mul_f32 v2, s88, v2
    v_mov_b32 v116, v3
    v_exp_f32 v2, v2
    v_fma_f32 v124, v120, s88, v4
    v_fma_f32 v125, v121, s88, v4
    v_fma_f32 v126, v122, s88, v4
    v_fma_f32 v127, v123, s88, v4
    v_exp_f32 v124, v124
    v_exp_f32 v125, v125
    v_exp_f32 v126, v126
    v_exp_f32 v127, v127
    v_pk_mul_f32 v[104:105], v[104:105], v[2:3] op_sel_hi:[1,0]
    v_pk_mul_f32 v[106:107], v[106:107], v[2:3] op_sel_hi:[1,0]
    v_pk_mul_f32 v[108:109], v[108:109], v[2:3] op_sel_hi:[1,0]
    v_pk_mul_f32 v[110:111], v[110:111], v[2:3] op_sel_hi:[1,0]
    v_fma_f32 v117, v117, v2, v124
    v_add_f32 v3, v125, v126
    v_add_f32 v117, v117, v127
    v_add_f32 v117, v117, v3
    s_waitcnt vmcnt(16)
    v_lshlrev_b32 v8, 16, v32
    v_and_b32 v9, s86, v32
    v_lshlrev_b32 v10, 16, v33
    v_and_b32 v11, s86, v33
    v_lshlrev_b32 v12, 16, v34
    v_and_b32 v13, s86, v34
    v_lshlrev_b32 v14, 16, v35
    v_and_b32 v15, s86, v35
    buffer_load_dwordx4 v[32:35], v1, s[36:39], s81 offen offset:0 sc1 nt
    v_pk_fma_f32 v[104:105], v[8:9], v[124:125], v[104:105] op_sel_hi:[1,0,1]
    v_pk_fma_f32 v[106:107], v[10:11], v[124:125], v[106:107] op_sel_hi:[1,0,1]
    v_pk_fma_f32 v[108:109], v[12:13], v[124:125], v[108:109] op_sel_hi:[1,0,1]
    v_pk_fma_f32 v[110:111], v[14:15], v[124:125], v[110:111] op_sel_hi:[1,0,1]
    s_waitcnt vmcnt(16)
    v_lshlrev_b32 v8, 16, v36
    v_and_b32 v9, s86, v36
    v_lshlrev_b32 v10, 16, v37
    v_and_b32 v11, s86, v37
    v_lshlrev_b32 v12, 16, v38
    v_and_b32 v13, s86, v38
    v_lshlrev_b32 v14, 16, v39
    v_and_b32 v15, s86, v39
    buffer_load_dwordx4 v[36:39], v1, s[36:39], s81 offen offset:1024 sc1 nt
    v_pk_fma_f32 v[104:105], v[8:9], v[124:125], v[104:105] op_sel:[0,1,0] op_sel_hi:[1,1,1]
    v_pk_fma_f32 v[106:107], v[10:11], v[124:125], v[106:107] op_sel:[0,1,0] op_sel_hi:[1,1,1]
    v_pk_fma_f32 v[108:109], v[12:13], v[124:125], v[108:109] op_sel:[0,1,0] op_sel_hi:[1,1,1]
    v_pk_fma_f32 v[110:111], v[14:15], v[124:125], v[110:111] op_sel:[0,1,0] op_sel_hi:[1,1,1]
    s_waitcnt vmcnt(16)
    v_lshlrev_b32 v8, 16, v40
    v_and_b32 v9, s86, v40
    v_lshlrev_b32 v10, 16, v41
    v_and_b32 v11, s86, v41
    v_lshlrev_b32 v12, 16, v42
    v_and_b32 v13, s86, v42
    v_lshlrev_b32 v14, 16, v43
    v_and_b32 v15, s86, v43
    buffer_load_dwordx4 v[40:43], v1, s[36:39], s81 offen offset:2048 sc1 nt
    v_pk_fma_f32 v[104:105], v[8:9], v[126:127], v[104:105] op_sel_hi:[1,0,1]
    v_pk_fma_f32 v[106:107], v[10:11], v[126:127], v[106:107] op_sel_hi:[1,0,1]
    v_pk_fma_f32 v[108:109], v[12:13], v[126:127], v[108:109] op_sel_hi:[1,0,1]
    v_pk_fma_f32 v[110:111], v[14:15], v[126:127], v[110:111] op_sel_hi:[1,0,1]
    s_waitcnt vmcnt(16)
    v_lshlrev_b32 v8, 16, v44
    v_and_b32 v9, s86, v44
    v_lshlrev_b32 v10, 16, v45
    v_and_b32 v11, s86, v45
    v_lshlrev_b32 v12, 16, v46
    v_and_b32 v13, s86, v46
    v_lshlrev_b32 v14, 16, v47
    v_and_b32 v15, s86, v47
    buffer_load_dwordx4 v[44:47], v1, s[36:39], s81 offen offset:3072 sc1 nt
    v_pk_fma_f32 v[104:105], v[8:9], v[126:127], v[104:105] op_sel:[0,1,0] op_sel_hi:[1,1,1]
    v_pk_fma_f32 v[106:107], v[10:11], v[126:127], v[106:107] op_sel:[0,1,0] op_sel_hi:[1,1,1]
    v_pk_fma_f32 v[108:109], v[12:13], v[126:127], v[108:109] op_sel:[0,1,0] op_sel_hi:[1,1,1]
    v_pk_fma_f32 v[110:111], v[14:15], v[126:127], v[110:111] op_sel:[0,1,0] op_sel_hi:[1,1,1]
    s_waitcnt vmcnt(16)
    v_dot2_f32_bf16 v120, v80, v112, 0
    v_dot2_f32_bf16 v120, v81, v113, v120
    v_dot2_f32_bf16 v120, v82, v114, v120
    v_dot2_f32_bf16 v120, v83, v115, v120
    s_waitcnt vmcnt(15)
    v_dot2_f32_bf16 v121, v84, v112, 0
    v_dot2_f32_bf16 v121, v85, v113, v121
    v_dot2_f32_bf16 v121, v86, v114, v121
    v_dot2_f32_bf16 v121, v87, v115, v121
    s_waitcnt vmcnt(14)
    v_dot2_f32_bf16 v122, v88, v112, 0
    v_dot2_f32_bf16 v122, v89, v113, v122
    v_dot2_f32_bf16 v122, v90, v114, v122
    v_dot2_f32_bf16 v122, v91, v115, v122
    s_waitcnt vmcnt(13)
    v_dot2_f32_bf16 v123, v92, v112, 0
    v_dot2_f32_bf16 v123, v93, v113, v123
    v_dot2_f32_bf16 v123, v94, v114, v123
    v_dot2_f32_bf16 v123, v95, v115, v123
    v_add_f32_dpp v120, v120, v120 row_ror:8 row_mask:0xf bank_mask:0xf
    v_add_f32_dpp v121, v121, v121 row_ror:8 row_mask:0xf bank_mask:0xf
    v_add_f32_dpp v122, v122, v122 row_ror:8 row_mask:0xf bank_mask:0xf
    v_add_f32_dpp v123, v123, v123 row_ror:8 row_mask:0xf bank_mask:0xf
    v_add_f32_dpp v120, v120, v120 row_ror:4 row_mask:0xf bank_mask:0xf
    v_add_f32_dpp v121, v121, v121 row_ror:4 row_mask:0xf bank_mask:0xf
    v_add_f32_dpp v122, v122, v122 row_ror:4 row_mask:0xf bank_mask:0xf
    v_add_f32_dpp v123, v123, v123 row_ror:4 row_mask:0xf bank_mask:0xf
    v_add_f32_dpp v120, v120, v120 row_ror:2 row_mask:0xf bank_mask:0xf
    v_add_f32_dpp v121, v121, v121 row_ror:2 row_mask:0xf bank_mask:0xf
    v_add_f32_dpp v122, v122, v122 row_ror:2 row_mask:0xf bank_mask:0xf
    v_add_f32_dpp v123, v123, v123 row_ror:2 row_mask:0xf bank_mask:0xf
    v_add_f32_dpp v120, v120, v120 row_ror:1 row_mask:0xf bank_mask:0xf
    v_add_f32_dpp v121, v121, v121 row_ror:1 row_mask:0xf bank_mask:0xf
    v_add_f32_dpp v122, v122, v122 row_ror:1 row_mask:0xf bank_mask:0xf
    v_add_f32_dpp v123, v123, v123 row_ror:1 row_mask:0xf bank_mask:0xf
    v_max3_f32 v3, v120, v121, v116
    v_max3_f32 v3, v122, v123, v3
    v_sub_f32 v2, v116, v3
    v_mul_f32 v4, s89, v3
    v_mul_f32 v2, s88, v2
    v_mov_b32 v116, v3
    v_exp_f32 v2, v2
    v_fma_f32 v124, v120, s88, v4
    v_fma_f32 v125, v121, s88, v4
    v_fma_f32 v126, v122, s88, v4
    v_fma_f32 v127, v123, s88, v4
    v_exp_f32 v124, v124
    v_exp_f32 v125, v125
    v_exp_f32 v126, v126
    v_exp_f32 v127, v127
    v_pk_mul_f32 v[104:105], v[104:105], v[2:3] op_sel_hi:[1,0]
    v_pk_mul_f32 v[106:107], v[106:107], v[2:3] op_sel_hi:[1,0]
    v_pk_mul_f32 v[108:109], v[108:109], v[2:3] op_sel_hi:[1,0]
    v_pk_mul_f32 v[110:111], v[110:111], v[2:3] op_sel_hi:[1,0]
    v_fma_f32 v117, v117, v2, v124
    v_add_f32 v3, v125, v126
    v_add_f32 v117, v117, v127
    v_add_f32 v117, v117, v3
    s_waitcnt vmcnt(12)
    v_lshlrev_b32 v8, 16, v64
    v_and_b32 v9, s86, v64
    v_lshlrev_b32 v10, 16, v65
    v_and_b32 v11, s86, v65
    v_lshlrev_b32 v12, 16, v66
    v_and_b32 v13, s86, v66
    v_lshlrev_b32 v14, 16, v67
    v_and_b32 v15, s86, v67
    v_pk_fma_f32 v[104:105], v[8:9], v[124:125], v[104:105] op_sel_hi:[1,0,1]
    v_pk_fma_f32 v[106:107], v[10:11], v[124:125], v[106:107] op_sel_hi:[1,0,1]
    v_pk_fma_f32 v[108:109], v[12:13], v[124:125], v[108:109] op_sel_hi:[1,0,1]
    v_pk_fma_f32 v[110:111], v[14:15], v[124:125], v[110:111] op_sel_hi:[1,0,1]
    s_waitcnt vmcnt(11)
    v_lshlrev_b32 v8, 16, v68
    v_and_b32 v9, s86, v68
    v_lshlrev_b32 v10, 16, v69
    v_and_b32 v11, s86, v69
    v_lshlrev_b32 v12, 16, v70
    v_and_b32 v13, s86, v70
    v_lshlrev_b32 v14, 16, v71
    v_and_b32 v15, s86, v71
    v_pk_fma_f32 v[104:105], v[8:9], v[124:125], v[104:105] op_sel:[0,1,0] op_sel_hi:[1,1,1]
    v_pk_fma_f32 v[106:107], v[10:11], v[124:125], v[106:107] op_sel:[0,1,0] op_sel_hi:[1,1,1]
    v_pk_fma_f32 v[108:109], v[12:13], v[124:125], v[108:109] op_sel:[0,1,0] op_sel_hi:[1,1,1]
    v_pk_fma_f32 v[110:111], v[14:15], v[124:125], v[110:111] op_sel:[0,1,0] op_sel_hi:[1,1,1]
    s_waitcnt vmcnt(10)
    v_lshlrev_b32 v8, 16, v72
    v_and_b32 v9, s86, v72
    v_lshlrev_b32 v10, 16, v73
    v_and_b32 v11, s86, v73
    v_lshlrev_b32 v12, 16, v74
    v_and_b32 v13, s86, v74
    v_lshlrev_b32 v14, 16, v75
    v_and_b32 v15, s86, v75
    v_pk_fma_f32 v[104:105], v[8:9], v[126:127], v[104:105] op_sel_hi:[1,0,1]
    v_pk_fma_f32 v[106:107], v[10:11], v[126:127], v[106:107] op_sel_hi:[1,0,1]
    v_pk_fma_f32 v[108:109], v[12:13], v[126:127], v[108:109] op_sel_hi:[1,0,1]
    v_pk_fma_f32 v[110:111], v[14:15], v[126:127], v[110:111] op_sel_hi:[1,0,1]
    s_waitcnt vmcnt(9)
    v_lshlrev_b32 v8, 16, v76
    v_and_b32 v9, s86, v76
    v_lshlrev_b32 v10, 16, v77
    v_and_b32 v11, s86, v77
    v_lshlrev_b32 v12, 16, v78
    v_and_b32 v13, s86, v78
    v_lshlrev_b32 v14, 16, v79
    v_and_b32 v15, s86, v79
    v_pk_fma_f32 v[104:105], v[8:9], v[126:127], v[104:105] op_sel:[0,1,0] op_sel_hi:[1,1,1]
    v_pk_fma_f32 v[106:107], v[10:11], v[126:127], v[106:107] op_sel:[0,1,0] op_sel_hi:[1,1,1]
    v_pk_fma_f32 v[108:109], v[12:13], v[126:127], v[108:109] op_sel:[0,1,0] op_sel_hi:[1,1,1]
    v_pk_fma_f32 v[110:111], v[14:15], v[126:127], v[110:111] op_sel:[0,1,0] op_sel_hi:[1,1,1]
    buffer_load_dwordx4 v[80:83], v103, s[52:55], 0 offen
    buffer_load_dwordx4 v[84:87], v103, s[52:55], s94 offen
    s_add_u32 s81, s81, 0x10000
    s_waitcnt vmcnt(9)
    v_dot2_f32_bf16 v120, v16, v112, 0
    v_dot2_f32_bf16 v120, v17, v113, v120
    v_dot2_f32_bf16 v120, v18, v114, v120
    v_dot2_f32_bf16 v120, v19, v115, v120
    buffer_load_dwordx4 v[16:19], v1, s[32:35], s81 offen offset:0 sc1 nt
    s_waitcnt vmcnt(9)
    v_dot2_f32_bf16 v121, v20, v112, 0
    v_dot2_f32_bf16 v121, v21, v113, v121
    v_dot2_f32_bf16 v121, v22, v114, v121
    v_dot2_f32_bf16 v121, v23, v115, v121
    buffer_load_dwordx4 v[20:23], v1, s[32:35], s81 offen offset:1024 sc1 nt
    s_waitcnt vmcnt(9)
    v_dot2_f32_bf16 v122, v24, v112, 0
    v_dot2_f32_bf16 v122, v25, v113, v122
    v_dot2_f32_bf16 v122, v26, v114, v122
    v_dot2_f32_bf16 v122, v27, v115, v122
    buffer_load_dwordx4 v[24:27], v1, s[32:35], s81 offen offset:2048 sc1 nt
    s_waitcnt vmcnt(9)
    v_dot2_f32_bf16 v123, v28, v112, 0
    v_dot2_f32_bf16 v123, v29, v113, v123
    v_dot2_f32_bf16 v123, v30, v114, v123
    v_dot2_f32_bf16 v123, v31, v115, v123
    buffer_load_dwordx4 v[28:31], v1, s[32:35], s81 offen offset:3072 sc1 nt
    v_add_f32_dpp v120, v120, v120 row_ror:8 row_mask:0xf bank_mask:0xf
    v_add_f32_dpp v121, v121, v121 row_ror:8 row_mask:0xf bank_mask:0xf
    v_add_f32_dpp v122, v122, v122 row_ror:8 row_mask:0xf bank_mask:0xf
    v_add_f32_dpp v123, v123, v123 row_ror:8 row_mask:0xf bank_mask:0xf
    v_add_f32_dpp v120, v120, v120 row_ror:4 row_mask:0xf bank_mask:0xf
    v_add_f32_dpp v121, v121, v121 row_ror:4 row_mask:0xf bank_mask:0xf
    v_add_f32_dpp v122, v122, v122 row_ror:4 row_mask:0xf bank_mask:0xf
    v_add_f32_dpp v123, v123, v123 row_ror:4 row_mask:0xf bank_mask:0xf
    v_add_f32_dpp v120, v120, v120 row_ror:2 row_mask:0xf bank_mask:0xf
    v_add_f32_dpp v121, v121, v121 row_ror:2 row_mask:0xf bank_mask:0xf
    v_add_f32_dpp v122, v122, v122 row_ror:2 row_mask:0xf bank_mask:0xf
    v_add_f32_dpp v123, v123, v123 row_ror:2 row_mask:0xf bank_mask:0xf
    v_add_f32_dpp v120, v120, v120 row_ror:1 row_mask:0xf bank_mask:0xf
    v_add_f32_dpp v121, v121, v121 row_ror:1 row_mask:0xf bank_mask:0xf
    v_add_f32_dpp v122, v122, v122 row_ror:1 row_mask:0xf bank_mask:0xf
    v_add_f32_dpp v123, v123, v123 row_ror:1 row_mask:0xf bank_mask:0xf
    v_max3_f32 v3, v120, v121, v116
    v_max3_f32 v3, v122, v123, v3
    v_sub_f32 v2, v116, v3
    v_mul_f32 v4, s89, v3
    v_mul_f32 v2, s88, v2
    v_mov_b32 v116, v3
    v_exp_f32 v2, v2
    v_fma_f32 v124, v120, s88, v4
    v_fma_f32 v125, v121, s88, v4
    v_fma_f32 v126, v122, s88, v4
    v_fma_f32 v127, v123, s88, v4
    v_exp_f32 v124, v124
    v_exp_f32 v125, v125
    v_exp_f32 v126, v126
    v_exp_f32 v127, v127
    v_pk_mul_f32 v[104:105], v[104:105], v[2:3] op_sel_hi:[1,0]
    v_pk_mul_f32 v[106:107], v[106:107], v[2:3] op_sel_hi:[1,0]
    v_pk_mul_f32 v[108:109], v[108:109], v[2:3] op_sel_hi:[1,0]
    v_pk_mul_f32 v[110:111], v[110:111], v[2:3] op_sel_hi:[1,0]
    v_fma_f32 v117, v117, v2, v124
    v_add_f32 v3, v125, v126
    v_add_f32 v117, v117, v127
    v_add_f32 v117, v117, v3
    s_waitcnt vmcnt(9)
    v_lshlrev_b32 v8, 16, v32
    v_and_b32 v9, s86, v32
    v_lshlrev_b32 v10, 16, v33
    v_and_b32 v11, s86, v33
    v_lshlrev_b32 v12, 16, v34
    v_and_b32 v13, s86, v34
    v_lshlrev_b32 v14, 16, v35
    v_and_b32 v15, s86, v35
    buffer_load_dwordx4 v[32:35], v1, s[36:39], s81 offen offset:0 sc1 nt
    v_pk_fma_f32 v[104:105], v[8:9], v[124:125], v[104:105] op_sel_hi:[1,0,1]
    v_pk_fma_f32 v[106:107], v[10:11], v[124:125], v[106:107] op_sel_hi:[1,0,1]
    v_pk_fma_f32 v[108:109], v[12:13], v[124:125], v[108:109] op_sel_hi:[1,0,1]
    v_pk_fma_f32 v[110:111], v[14:15], v[124:125], v[110:111] op_sel_hi:[1,0,1]
    s_waitcnt vmcnt(9)
    v_lshlrev_b32 v8, 16, v36
    v_and_b32 v9, s86, v36
    v_lshlrev_b32 v10, 16, v37
    v_and_b32 v11, s86, v37
    v_lshlrev_b32 v12, 16, v38
    v_and_b32 v13, s86, v38
    v_lshlrev_b32 v14, 16, v39
    v_and_b32 v15, s86, v39
    buffer_load_dwordx4 v[36:39], v1, s[36:39], s81 offen offset:1024 sc1 nt
    v_pk_fma_f32 v[104:105], v[8:9], v[124:125], v[104:105] op_sel:[0,1,0] op_sel_hi:[1,1,1]
    v_pk_fma_f32 v[106:107], v[10:11], v[124:125], v[106:107] op_sel:[0,1,0] op_sel_hi:[1,1,1]
    v_pk_fma_f32 v[108:109], v[12:13], v[124:125], v[108:109] op_sel:[0,1,0] op_sel_hi:[1,1,1]
    v_pk_fma_f32 v[110:111], v[14:15], v[124:125], v[110:111] op_sel:[0,1,0] op_sel_hi:[1,1,1]
    s_waitcnt vmcnt(9)
    v_lshlrev_b32 v8, 16, v40
    v_and_b32 v9, s86, v40
    v_lshlrev_b32 v10, 16, v41
    v_and_b32 v11, s86, v41
    v_lshlrev_b32 v12, 16, v42
    v_and_b32 v13, s86, v42
    v_lshlrev_b32 v14, 16, v43
    v_and_b32 v15, s86, v43
    buffer_load_dwordx4 v[40:43], v1, s[36:39], s81 offen offset:2048 sc1 nt
    v_pk_fma_f32 v[104:105], v[8:9], v[126:127], v[104:105] op_sel_hi:[1,0,1]
    v_pk_fma_f32 v[106:107], v[10:11], v[126:127], v[106:107] op_sel_hi:[1,0,1]
    v_pk_fma_f32 v[108:109], v[12:13], v[126:127], v[108:109] op_sel_hi:[1,0,1]
    v_pk_fma_f32 v[110:111], v[14:15], v[126:127], v[110:111] op_sel_hi:[1,0,1]
    s_waitcnt vmcnt(9)
    v_lshlrev_b32 v8, 16, v44
    v_and_b32 v9, s86, v44
    v_lshlrev_b32 v10, 16, v45
    v_and_b32 v11, s86, v45
    v_lshlrev_b32 v12, 16, v46
    v_and_b32 v13, s86, v46
    v_lshlrev_b32 v14, 16, v47
    v_and_b32 v15, s86, v47
    buffer_load_dwordx4 v[44:47], v1, s[36:39], s81 offen offset:3072 sc1 nt
    v_pk_fma_f32 v[104:105], v[8:9], v[126:127], v[104:105] op_sel:[0,1,0] op_sel_hi:[1,1,1]
    v_pk_fma_f32 v[106:107], v[10:11], v[126:127], v[106:107] op_sel:[0,1,0] op_sel_hi:[1,1,1]
    v_pk_fma_f32 v[108:109], v[12:13], v[126:127], v[108:109] op_sel:[0,1,0] op_sel_hi:[1,1,1]
    v_pk_fma_f32 v[110:111], v[14:15], v[126:127], v[110:111] op_sel:[0,1,0] op_sel_hi:[1,1,1]
    buffer_load_dwordx4 v[88:91], v103, s[52:55], s95 offen
    buffer_load_dwordx4 v[92:95], v103, s[52:55], s96 offen
    s_add_u32 s81, s81, 0x10000
    s_waitcnt vmcnt(9)
    v_dot2_f32_bf16 v120, v16, v112, 0
    v_dot2_f32_bf16 v120, v17, v113, v120
    v_dot2_f32_bf16 v120, v18, v114, v120
    v_dot2_f32_bf16 v120, v19, v115, v120
    buffer_load_dwordx4 v[16:19], v1, s[32:35], s81 offen offset:0 sc1 nt
    s_waitcnt vmcnt(9)
    v_dot2_f32_bf16 v121, v20, v112, 0
    v_dot2_f32_bf16 v121, v21, v113, v121
    v_dot2_f32_bf16 v121, v22, v114, v121
    v_dot2_f32_bf16 v121, v23, v115, v121
    buffer_load_dwordx4 v[20:23], v1, s[32:35], s81 offen offset:1024 sc1 nt
    s_waitcnt vmcnt(9)
    v_dot2_f32_bf16 v122, v24, v112, 0
    v_dot2_f32_bf16 v122, v25, v113, v122
    v_dot2_f32_bf16 v122, v26, v114, v122
    v_dot2_f32_bf16 v122, v27, v115, v122
    buffer_load_dwordx4 v[24:27], v1, s[32:35], s81 offen offset:2048 sc1 nt
    s_waitcnt vmcnt(9)
    v_dot2_f32_bf16 v123, v28, v112, 0
    v_dot2_f32_bf16 v123, v29, v113, v123
    v_dot2_f32_bf16 v123, v30, v114, v123
    v_dot2_f32_bf16 v123, v31, v115, v123
    buffer_load_dwordx4 v[28:31], v1, s[32:35], s81 offen offset:3072 sc1 nt
    v_add_f32_dpp v120, v120, v120 row_ror:8 row_mask:0xf bank_mask:0xf
    v_add_f32_dpp v121, v121, v121 row_ror:8 row_mask:0xf bank_mask:0xf
    v_add_f32_dpp v122, v122, v122 row_ror:8 row_mask:0xf bank_mask:0xf
    v_add_f32_dpp v123, v123, v123 row_ror:8 row_mask:0xf bank_mask:0xf
    v_add_f32_dpp v120, v120, v120 row_ror:4 row_mask:0xf bank_mask:0xf
    v_add_f32_dpp v121, v121, v121 row_ror:4 row_mask:0xf bank_mask:0xf
    v_add_f32_dpp v122, v122, v122 row_ror:4 row_mask:0xf bank_mask:0xf
    v_add_f32_dpp v123, v123, v123 row_ror:4 row_mask:0xf bank_mask:0xf
    v_add_f32_dpp v120, v120, v120 row_ror:2 row_mask:0xf bank_mask:0xf
    v_add_f32_dpp v121, v121, v121 row_ror:2 row_mask:0xf bank_mask:0xf
    v_add_f32_dpp v122, v122, v122 row_ror:2 row_mask:0xf bank_mask:0xf
    v_add_f32_dpp v123, v123, v123 row_ror:2 row_mask:0xf bank_mask:0xf
    v_add_f32_dpp v120, v120, v120 row_ror:1 row_mask:0xf bank_mask:0xf
    v_add_f32_dpp v121, v121, v121 row_ror:1 row_mask:0xf bank_mask:0xf
    v_add_f32_dpp v122, v122, v122 row_ror:1 row_mask:0xf bank_mask:0xf
    v_add_f32_dpp v123, v123, v123 row_ror:1 row_mask:0xf bank_mask:0xf
    v_max3_f32 v3, v120, v121, v116
    v_max3_f32 v3, v122, v123, v3
    v_sub_f32 v2, v116, v3
    v_mul_f32 v4, s89, v3
    v_mul_f32 v2, s88, v2
    v_mov_b32 v116, v3
    v_exp_f32 v2, v2
    v_fma_f32 v124, v120, s88, v4
    v_fma_f32 v125, v121, s88, v4
    v_fma_f32 v126, v122, s88, v4
    v_fma_f32 v127, v123, s88, v4
    v_exp_f32 v124, v124
    v_exp_f32 v125, v125
    v_exp_f32 v126, v126
    v_exp_f32 v127, v127
    v_pk_mul_f32 v[104:105], v[104:105], v[2:3] op_sel_hi:[1,0]
    v_pk_mul_f32 v[106:107], v[106:107], v[2:3] op_sel_hi:[1,0]
    v_pk_mul_f32 v[108:109], v[108:109], v[2:3] op_sel_hi:[1,0]
    v_pk_mul_f32 v[110:111], v[110:111], v[2:3] op_sel_hi:[1,0]
    v_fma_f32 v117, v117, v2, v124
    v_add_f32 v3, v125, v126
    v_add_f32 v117, v117, v127
    v_add_f32 v117, v117, v3
    s_waitcnt vmcnt(9)
    v_lshlrev_b32 v8, 16, v32
    v_and_b32 v9, s86, v32
    v_lshlrev_b32 v10, 16, v33
    v_and_b32 v11, s86, v33
    v_lshlrev_b32 v12, 16, v34
    v_and_b32 v13, s86, v34
    v_lshlrev_b32 v14, 16, v35
    v_and_b32 v15, s86, v35
    buffer_load_dwordx4 v[32:35], v1, s[36:39], s81 offen offset:0 sc1 nt
    v_pk_fma_f32 v[104:105], v[8:9], v[124:125], v[104:105] op_sel_hi:[1,0,1]
    v_pk_fma_f32 v[106:107], v[10:11], v[124:125], v[106:107] op_sel_hi:[1,0,1]
    v_pk_fma_f32 v[108:109], v[12:13], v[124:125], v[108:109] op_sel_hi:[1,0,1]
    v_pk_fma_f32 v[110:111], v[14:15], v[124:125], v[110:111] op_sel_hi:[1,0,1]
    s_waitcnt vmcnt(9)
    v_lshlrev_b32 v8, 16, v36
    v_and_b32 v9, s86, v36
    v_lshlrev_b32 v10, 16, v37
    v_and_b32 v11, s86, v37
    v_lshlrev_b32 v12, 16, v38
    v_and_b32 v13, s86, v38
    v_lshlrev_b32 v14, 16, v39
    v_and_b32 v15, s86, v39
    buffer_load_dwordx4 v[36:39], v1, s[36:39], s81 offen offset:1024 sc1 nt
    v_pk_fma_f32 v[104:105], v[8:9], v[124:125], v[104:105] op_sel:[0,1,0] op_sel_hi:[1,1,1]
    v_pk_fma_f32 v[106:107], v[10:11], v[124:125], v[106:107] op_sel:[0,1,0] op_sel_hi:[1,1,1]
    v_pk_fma_f32 v[108:109], v[12:13], v[124:125], v[108:109] op_sel:[0,1,0] op_sel_hi:[1,1,1]
    v_pk_fma_f32 v[110:111], v[14:15], v[124:125], v[110:111] op_sel:[0,1,0] op_sel_hi:[1,1,1]
    s_waitcnt vmcnt(9)
    v_lshlrev_b32 v8, 16, v40
    v_and_b32 v9, s86, v40
    v_lshlrev_b32 v10, 16, v41
    v_and_b32 v11, s86, v41
    v_lshlrev_b32 v12, 16, v42
    v_and_b32 v13, s86, v42
    v_lshlrev_b32 v14, 16, v43
    v_and_b32 v15, s86, v43
    buffer_load_dwordx4 v[40:43], v1, s[36:39], s81 offen offset:2048 sc1 nt
    v_pk_fma_f32 v[104:105], v[8:9], v[126:127], v[104:105] op_sel_hi:[1,0,1]
    v_pk_fma_f32 v[106:107], v[10:11], v[126:127], v[106:107] op_sel_hi:[1,0,1]
    v_pk_fma_f32 v[108:109], v[12:13], v[126:127], v[108:109] op_sel_hi:[1,0,1]
    v_pk_fma_f32 v[110:111], v[14:15], v[126:127], v[110:111] op_sel_hi:[1,0,1]
    s_waitcnt vmcnt(9)
    v_lshlrev_b32 v8, 16, v44
    v_and_b32 v9, s86, v44
    v_lshlrev_b32 v10, 16, v45
    v_and_b32 v11, s86, v45
    v_lshlrev_b32 v12, 16, v46
    v_and_b32 v13, s86, v46
    v_lshlrev_b32 v14, 16, v47
    v_and_b32 v15, s86, v47
    buffer_load_dwordx4 v[44:47], v1, s[36:39], s81 offen offset:3072 sc1 nt
    v_pk_fma_f32 v[104:105], v[8:9], v[126:127], v[104:105] op_sel:[0,1,0] op_sel_hi:[1,1,1]
    v_pk_fma_f32 v[106:107], v[10:11], v[126:127], v[106:107] op_sel:[0,1,0] op_sel_hi:[1,1,1]
    v_pk_fma_f32 v[108:109], v[12:13], v[126:127], v[108:109] op_sel:[0,1,0] op_sel_hi:[1,1,1]
    v_pk_fma_f32 v[110:111], v[14:15], v[126:127], v[110:111] op_sel:[0,1,0] op_sel_hi:[1,1,1]
    buffer_load_dwordx4 v[96:99], v1, s[56:59], s99 offen offset:0
    s_add_u32 s81, s81, 0x10000
    s_waitcnt vmcnt(8)
    v_dot2_f32_bf16 v120, v16, v112, 0
    v_dot2_f32_bf16 v120, v17, v113, v120
    v_dot2_f32_bf16 v120, v18, v114, v120
    v_dot2_f32_bf16 v120, v19, v115, v120
    buffer_load_dwordx4 v[16:19], v1, s[32:35], s81 offen offset:0 sc1 nt
    s_waitcnt vmcnt(8)
    v_dot2_f32_bf16 v121, v20, v112, 0
    v_dot2_f32_bf16 v121, v21, v113, v121
    v_dot2_f32_bf16 v121, v22, v114, v121
    v_dot2_f32_bf16 v121, v23, v115, v121
    buffer_load_dwordx4 v[20:23], v1, s[32:35], s81 offen offset:1024 sc1 nt
    s_waitcnt vmcnt(8)
    v_dot2_f32_bf16 v122, v24, v112, 0
    v_dot2_f32_bf16 v122, v25, v113, v122
    v_dot2_f32_bf16 v122, v26, v114, v122
    v_dot2_f32_bf16 v122, v27, v115, v122
    buffer_load_dwordx4 v[24:27], v1, s[32:35], s81 offen offset:2048 sc1 nt
    s_waitcnt vmcnt(8)
    v_dot2_f32_bf16 v123, v28, v112, 0
    v_dot2_f32_bf16 v123, v29, v113, v123
    v_dot2_f32_bf16 v123, v30, v114, v123
    v_dot2_f32_bf16 v123, v31, v115, v123
    buffer_load_dwordx4 v[28:31], v1, s[32:35], s81 offen offset:3072 sc1 nt
    v_add_f32_dpp v120, v120, v120 row_ror:8 row_mask:0xf bank_mask:0xf
    v_add_f32_dpp v121, v121, v121 row_ror:8 row_mask:0xf bank_mask:0xf
    v_add_f32_dpp v122, v122, v122 row_ror:8 row_mask:0xf bank_mask:0xf
    v_add_f32_dpp v123, v123, v123 row_ror:8 row_mask:0xf bank_mask:0xf
    v_add_f32_dpp v120, v120, v120 row_ror:4 row_mask:0xf bank_mask:0xf
    v_add_f32_dpp v121, v121, v121 row_ror:4 row_mask:0xf bank_mask:0xf
    v_add_f32_dpp v122, v122, v122 row_ror:4 row_mask:0xf bank_mask:0xf
    v_add_f32_dpp v123, v123, v123 row_ror:4 row_mask:0xf bank_mask:0xf
    v_add_f32_dpp v120, v120, v120 row_ror:2 row_mask:0xf bank_mask:0xf
    v_add_f32_dpp v121, v121, v121 row_ror:2 row_mask:0xf bank_mask:0xf
    v_add_f32_dpp v122, v122, v122 row_ror:2 row_mask:0xf bank_mask:0xf
    v_add_f32_dpp v123, v123, v123 row_ror:2 row_mask:0xf bank_mask:0xf
    v_add_f32_dpp v120, v120, v120 row_ror:1 row_mask:0xf bank_mask:0xf
    v_add_f32_dpp v121, v121, v121 row_ror:1 row_mask:0xf bank_mask:0xf
    v_add_f32_dpp v122, v122, v122 row_ror:1 row_mask:0xf bank_mask:0xf
    v_add_f32_dpp v123, v123, v123 row_ror:1 row_mask:0xf bank_mask:0xf
    v_max3_f32 v3, v120, v121, v116
    v_max3_f32 v3, v122, v123, v3
    v_sub_f32 v2, v116, v3
    v_mul_f32 v4, s89, v3
    v_mul_f32 v2, s88, v2
    v_mov_b32 v116, v3
    v_exp_f32 v2, v2
    v_fma_f32 v124, v120, s88, v4
    v_fma_f32 v125, v121, s88, v4
    v_fma_f32 v126, v122, s88, v4
    v_fma_f32 v127, v123, s88, v4
    v_exp_f32 v124, v124
    v_exp_f32 v125, v125
    v_exp_f32 v126, v126
    v_exp_f32 v127, v127
    v_pk_mul_f32 v[104:105], v[104:105], v[2:3] op_sel_hi:[1,0]
    v_pk_mul_f32 v[106:107], v[106:107], v[2:3] op_sel_hi:[1,0]
    v_pk_mul_f32 v[108:109], v[108:109], v[2:3] op_sel_hi:[1,0]
    v_pk_mul_f32 v[110:111], v[110:111], v[2:3] op_sel_hi:[1,0]
    v_fma_f32 v117, v117, v2, v124
    v_add_f32 v3, v125, v126
    v_add_f32 v117, v117, v127
    v_add_f32 v117, v117, v3
    s_waitcnt vmcnt(8)
    v_lshlrev_b32 v8, 16, v32
    v_and_b32 v9, s86, v32
    v_lshlrev_b32 v10, 16, v33
    v_and_b32 v11, s86, v33
    v_lshlrev_b32 v12, 16, v34
    v_and_b32 v13, s86, v34
    v_lshlrev_b32 v14, 16, v35
    v_and_b32 v15, s86, v35
    buffer_load_dwordx4 v[32:35], v1, s[36:39], s81 offen offset:0 sc1 nt
    v_pk_fma_f32 v[104:105], v[8:9], v[124:125], v[104:105] op_sel_hi:[1,0,1]
    v_pk_fma_f32 v[106:107], v[10:11], v[124:125], v[106:107] op_sel_hi:[1,0,1]
    v_pk_fma_f32 v[108:109], v[12:13], v[124:125], v[108:109] op_sel_hi:[1,0,1]
    v_pk_fma_f32 v[110:111], v[14:15], v[124:125], v[110:111] op_sel_hi:[1,0,1]
    s_waitcnt vmcnt(8)
    v_lshlrev_b32 v8, 16, v36
    v_and_b32 v9, s86, v36
    v_lshlrev_b32 v10, 16, v37
    v_and_b32 v11, s86, v37
    v_lshlrev_b32 v12, 16, v38
    v_and_b32 v13, s86, v38
    v_lshlrev_b32 v14, 16, v39
    v_and_b32 v15, s86, v39
    buffer_load_dwordx4 v[36:39], v1, s[36:39], s81 offen offset:1024 sc1 nt
    v_pk_fma_f32 v[104:105], v[8:9], v[124:125], v[104:105] op_sel:[0,1,0] op_sel_hi:[1,1,1]
    v_pk_fma_f32 v[106:107], v[10:11], v[124:125], v[106:107] op_sel:[0,1,0] op_sel_hi:[1,1,1]
    v_pk_fma_f32 v[108:109], v[12:13], v[124:125], v[108:109] op_sel:[0,1,0] op_sel_hi:[1,1,1]
    v_pk_fma_f32 v[110:111], v[14:15], v[124:125], v[110:111] op_sel:[0,1,0] op_sel_hi:[1,1,1]
    s_waitcnt vmcnt(8)
    v_lshlrev_b32 v8, 16, v40
    v_and_b32 v9, s86, v40
    v_lshlrev_b32 v10, 16, v41
    v_and_b32 v11, s86, v41
    v_lshlrev_b32 v12, 16, v42
    v_and_b32 v13, s86, v42
    v_lshlrev_b32 v14, 16, v43
    v_and_b32 v15, s86, v43
    buffer_load_dwordx4 v[40:43], v1, s[36:39], s81 offen offset:2048 sc1 nt
    v_pk_fma_f32 v[104:105], v[8:9], v[126:127], v[104:105] op_sel_hi:[1,0,1]
    v_pk_fma_f32 v[106:107], v[10:11], v[126:127], v[106:107] op_sel_hi:[1,0,1]
    v_pk_fma_f32 v[108:109], v[12:13], v[126:127], v[108:109] op_sel_hi:[1,0,1]
    v_pk_fma_f32 v[110:111], v[14:15], v[126:127], v[110:111] op_sel_hi:[1,0,1]
    s_waitcnt vmcnt(8)
    v_lshlrev_b32 v8, 16, v44
    v_and_b32 v9, s86, v44
    v_lshlrev_b32 v10, 16, v45
    v_and_b32 v11, s86, v45
    v_lshlrev_b32 v12, 16, v46
    v_and_b32 v13, s86, v46
    v_lshlrev_b32 v14, 16, v47
    v_and_b32 v15, s86, v47
    buffer_load_dwordx4 v[44:47], v1, s[36:39], s81 offen offset:3072 sc1 nt
    v_pk_fma_f32 v[104:105], v[8:9], v[126:127], v[104:105] op_sel:[0,1,0] op_sel_hi:[1,1,1]
    v_pk_fma_f32 v[106:107], v[10:11], v[126:127], v[106:107] op_sel:[0,1,0] op_sel_hi:[1,1,1]
    v_pk_fma_f32 v[108:109], v[12:13], v[126:127], v[108:109] op_sel:[0,1,0] op_sel_hi:[1,1,1]
    v_pk_fma_f32 v[110:111], v[14:15], v[126:127], v[110:111] op_sel:[0,1,0] op_sel_hi:[1,1,1]
    buffer_load_dwordx4 v[100:103], v1, s[56:59], s99 offen offset:1024
    s_lshl_b32 s98, s77, 17
    s_lshl_b32 s97, s3, 13
    s_add_u32 s98, s98, s97
    s_add_u32 s99, s98, 4096
    buffer_load_dwordx4 v[48:51], v1, s[44:47], s98 offen offset:0
    s_setprio 2
    s_add_u32 s81, s81, 0x10000
    s_waitcnt vmcnt(9)
    v_dot2_f32_bf16 v120, v16, v112, 0
    v_dot2_f32_bf16 v120, v17, v113, v120
    v_dot2_f32_bf16 v120, v18, v114, v120
    v_dot2_f32_bf16 v120, v19, v115, v120
    buffer_load_dwordx4 v[16:19], v1, s[32:35], s81 offen offset:0 sc1 nt
    s_waitcnt vmcnt(9)
    v_dot2_f32_bf16 v121, v20, v112, 0
    v_dot2_f32_bf16 v121, v21, v113, v121
    v_dot2_f32_bf16 v121, v22, v114, v121
    v_dot2_f32_bf16 v121, v23, v115, v121
    buffer_load_dwordx4 v[20:23], v1, s[32:35], s81 offen offset:1024 sc1 nt
    s_waitcnt vmcnt(9)
    v_dot2_f32_bf16 v122, v24, v112, 0
    v_dot2_f32_bf16 v122, v25, v113, v122
    v_dot2_f32_bf16 v122, v26, v114, v122
    v_dot2_f32_bf16 v122, v27, v115, v122
    buffer_load_dwordx4 v[24:27], v1, s[32:35], s81 offen offset:2048 sc1 nt
    s_waitcnt vmcnt(9)
    v_dot2_f32_bf16 v123, v28, v112, 0
    v_dot2_f32_bf16 v123, v29, v113, v123
    v_dot2_f32_bf16 v123, v30, v114, v123
    v_dot2_f32_bf16 v123, v31, v115, v123
    buffer_load_dwordx4 v[28:31], v1, s[32:35], s81 offen offset:3072 sc1 nt
    v_add_f32_dpp v120, v120, v120 row_ror:8 row_mask:0xf bank_mask:0xf
    v_add_f32_dpp v121, v121, v121 row_ror:8 row_mask:0xf bank_mask:0xf
    v_add_f32_dpp v122, v122, v122 row_ror:8 row_mask:0xf bank_mask:0xf
    v_add_f32_dpp v123, v123, v123 row_ror:8 row_mask:0xf bank_mask:0xf
    v_add_f32_dpp v120, v120, v120 row_ror:4 row_mask:0xf bank_mask:0xf
    v_add_f32_dpp v121, v121, v121 row_ror:4 row_mask:0xf bank_mask:0xf
    v_add_f32_dpp v122, v122, v122 row_ror:4 row_mask:0xf bank_mask:0xf
    v_add_f32_dpp v123, v123, v123 row_ror:4 row_mask:0xf bank_mask:0xf
    v_add_f32_dpp v120, v120, v120 row_ror:2 row_mask:0xf bank_mask:0xf
    v_add_f32_dpp v121, v121, v121 row_ror:2 row_mask:0xf bank_mask:0xf
    v_add_f32_dpp v122, v122, v122 row_ror:2 row_mask:0xf bank_mask:0xf
    v_add_f32_dpp v123, v123, v123 row_ror:2 row_mask:0xf bank_mask:0xf
    v_add_f32_dpp v120, v120, v120 row_ror:1 row_mask:0xf bank_mask:0xf
    v_add_f32_dpp v121, v121, v121 row_ror:1 row_mask:0xf bank_mask:0xf
    v_add_f32_dpp v122, v122, v122 row_ror:1 row_mask:0xf bank_mask:0xf
    v_add_f32_dpp v123, v123, v123 row_ror:1 row_mask:0xf bank_mask:0xf
    v_max3_f32 v3, v120, v121, v116
    v_max3_f32 v3, v122, v123, v3
    v_sub_f32 v2, v116, v3
    v_mul_f32 v4, s89, v3
    v_mul_f32 v2, s88, v2
    v_mov_b32 v116, v3
    v_exp_f32 v2, v2
    v_fma_f32 v124, v120, s88, v4
    v_fma_f32 v125, v121, s88, v4
    v_fma_f32 v126, v122, s88, v4
    v_fma_f32 v127, v123, s88, v4
    v_exp_f32 v124, v124
    v_exp_f32 v125, v125
    v_exp_f32 v126, v126
    v_exp_f32 v127, v127
    v_pk_mul_f32 v[104:105], v[104:105], v[2:3] op_sel_hi:[1,0]
    v_pk_mul_f32 v[106:107], v[106:107], v[2:3] op_sel_hi:[1,0]
    v_pk_mul_f32 v[108:109], v[108:109], v[2:3] op_sel_hi:[1,0]
    v_pk_mul_f32 v[110:111], v[110:111], v[2:3] op_sel_hi:[1,0]
    v_fma_f32 v117, v117, v2, v124
    v_add_f32 v3, v125, v126
    v_add_f32 v117, v117, v127
    v_add_f32 v117, v117, v3
    s_waitcnt vmcnt(9)
    v_lshlrev_b32 v8, 16, v32
    v_and_b32 v9, s86, v32
    v_lshlrev_b32 v10, 16, v33
    v_and_b32 v11, s86, v33
    v_lshlrev_b32 v12, 16, v34
    v_and_b32 v13, s86, v34
    v_lshlrev_b32 v14, 16, v35
    v_and_b32 v15, s86, v35
    buffer_load_dwordx4 v[32:35], v1, s[36:39], s81 offen offset:0 sc1 nt
    v_pk_fma_f32 v[104:105], v[8:9], v[124:125], v[104:105] op_sel_hi:[1,0,1]
    v_pk_fma_f32 v[106:107], v[10:11], v[124:125], v[106:107] op_sel_hi:[1,0,1]
    v_pk_fma_f32 v[108:109], v[12:13], v[124:125], v[108:109] op_sel_hi:[1,0,1]
    v_pk_fma_f32 v[110:111], v[14:15], v[124:125], v[110:111] op_sel_hi:[1,0,1]
    s_waitcnt vmcnt(9)
    v_lshlrev_b32 v8, 16, v36
    v_and_b32 v9, s86, v36
    v_lshlrev_b32 v10, 16, v37
    v_and_b32 v11, s86, v37
    v_lshlrev_b32 v12, 16, v38
    v_and_b32 v13, s86, v38
    v_lshlrev_b32 v14, 16, v39
    v_and_b32 v15, s86, v39
    buffer_load_dwordx4 v[36:39], v1, s[36:39], s81 offen offset:1024 sc1 nt
    v_pk_fma_f32 v[104:105], v[8:9], v[124:125], v[104:105] op_sel:[0,1,0] op_sel_hi:[1,1,1]
    v_pk_fma_f32 v[106:107], v[10:11], v[124:125], v[106:107] op_sel:[0,1,0] op_sel_hi:[1,1,1]
    v_pk_fma_f32 v[108:109], v[12:13], v[124:125], v[108:109] op_sel:[0,1,0] op_sel_hi:[1,1,1]
    v_pk_fma_f32 v[110:111], v[14:15], v[124:125], v[110:111] op_sel:[0,1,0] op_sel_hi:[1,1,1]
    s_waitcnt vmcnt(9)
    v_lshlrev_b32 v8, 16, v40
    v_and_b32 v9, s86, v40
    v_lshlrev_b32 v10, 16, v41
    v_and_b32 v11, s86, v41
    v_lshlrev_b32 v12, 16, v42
    v_and_b32 v13, s86, v42
    v_lshlrev_b32 v14, 16, v43
    v_and_b32 v15, s86, v43
    buffer_load_dwordx4 v[40:43], v1, s[36:39], s81 offen offset:2048 sc1 nt
    v_pk_fma_f32 v[104:105], v[8:9], v[126:127], v[104:105] op_sel_hi:[1,0,1]
    v_pk_fma_f32 v[106:107], v[10:11], v[126:127], v[106:107] op_sel_hi:[1,0,1]
    v_pk_fma_f32 v[108:109], v[12:13], v[126:127], v[108:109] op_sel_hi:[1,0,1]
    v_pk_fma_f32 v[110:111], v[14:15], v[126:127], v[110:111] op_sel_hi:[1,0,1]
    s_waitcnt vmcnt(9)
    v_lshlrev_b32 v8, 16, v44
    v_and_b32 v9, s86, v44
    v_lshlrev_b32 v10, 16, v45
    v_and_b32 v11, s86, v45
    v_lshlrev_b32 v12, 16, v46
    v_and_b32 v13, s86, v46
    v_lshlrev_b32 v14, 16, v47
    v_and_b32 v15, s86, v47
    buffer_load_dwordx4 v[44:47], v1, s[36:39], s81 offen offset:3072 sc1 nt
    v_pk_fma_f32 v[104:105], v[8:9], v[126:127], v[104:105] op_sel:[0,1,0] op_sel_hi:[1,1,1]
    v_pk_fma_f32 v[106:107], v[10:11], v[126:127], v[106:107] op_sel:[0,1,0] op_sel_hi:[1,1,1]
    v_pk_fma_f32 v[108:109], v[12:13], v[126:127], v[108:109] op_sel:[0,1,0] op_sel_hi:[1,1,1]
    v_pk_fma_f32 v[110:111], v[14:15], v[126:127], v[110:111] op_sel:[0,1,0] op_sel_hi:[1,1,1]
    buffer_load_dwordx4 v[52:55], v1, s[44:47], s98 offen offset:1024
    s_add_u32 s81, s81, 0x10000
    s_waitcnt vmcnt(8)
    v_dot2_f32_bf16 v120, v16, v112, 0
    v_dot2_f32_bf16 v120, v17, v113, v120
    v_dot2_f32_bf16 v120, v18, v114, v120
    v_dot2_f32_bf16 v120, v19, v115, v120
    buffer_load_dwordx4 v[16:19], v1, s[32:35], s81 offen offset:0 sc1 nt
    s_waitcnt vmcnt(8)
    v_dot2_f32_bf16 v121, v20, v112, 0
    v_dot2_f32_bf16 v121, v21, v113, v121
    v_dot2_f32_bf16 v121, v22, v114, v121
    v_dot2_f32_bf16 v121, v23, v115, v121
    buffer_load_dwordx4 v[20:23], v1, s[32:35], s81 offen offset:1024 sc1 nt
    s_waitcnt vmcnt(8)
    v_dot2_f32_bf16 v122, v24, v112, 0
    v_dot2_f32_bf16 v122, v25, v113, v122
    v_dot2_f32_bf16 v122, v26, v114, v122
    v_dot2_f32_bf16 v122, v27, v115, v122
    buffer_load_dwordx4 v[24:27], v1, s[32:35], s81 offen offset:2048 sc1 nt
    s_waitcnt vmcnt(8)
    v_dot2_f32_bf16 v123, v28, v112, 0
    v_dot2_f32_bf16 v123, v29, v113, v123
    v_dot2_f32_bf16 v123, v30, v114, v123
    v_dot2_f32_bf16 v123, v31, v115, v123
    buffer_load_dwordx4 v[28:31], v1, s[32:35], s81 offen offset:3072 sc1 nt
    v_add_f32_dpp v120, v120, v120 row_ror:8 row_mask:0xf bank_mask:0xf
    v_add_f32_dpp v121, v121, v121 row_ror:8 row_mask:0xf bank_mask:0xf
    v_add_f32_dpp v122, v122, v122 row_ror:8 row_mask:0xf bank_mask:0xf
    v_add_f32_dpp v123, v123, v123 row_ror:8 row_mask:0xf bank_mask:0xf
    v_add_f32_dpp v120, v120, v120 row_ror:4 row_mask:0xf bank_mask:0xf
    v_add_f32_dpp v121, v121, v121 row_ror:4 row_mask:0xf bank_mask:0xf
    v_add_f32_dpp v122, v122, v122 row_ror:4 row_mask:0xf bank_mask:0xf
    v_add_f32_dpp v123, v123, v123 row_ror:4 row_mask:0xf bank_mask:0xf
    v_add_f32_dpp v120, v120, v120 row_ror:2 row_mask:0xf bank_mask:0xf
    v_add_f32_dpp v121, v121, v121 row_ror:2 row_mask:0xf bank_mask:0xf
    v_add_f32_dpp v122, v122, v122 row_ror:2 row_mask:0xf bank_mask:0xf
    v_add_f32_dpp v123, v123, v123 row_ror:2 row_mask:0xf bank_mask:0xf
    v_add_f32_dpp v120, v120, v120 row_ror:1 row_mask:0xf bank_mask:0xf
    v_add_f32_dpp v121, v121, v121 row_ror:1 row_mask:0xf bank_mask:0xf
    v_add_f32_dpp v122, v122, v122 row_ror:1 row_mask:0xf bank_mask:0xf
    v_add_f32_dpp v123, v123, v123 row_ror:1 row_mask:0xf bank_mask:0xf
    v_max3_f32 v3, v120, v121, v116
    v_max3_f32 v3, v122, v123, v3
    v_sub_f32 v2, v116, v3
    v_mul_f32 v4, s89, v3
    v_mul_f32 v2, s88, v2
    v_mov_b32 v116, v3
    v_exp_f32 v2, v2
    v_fma_f32 v124, v120, s88, v4
    v_fma_f32 v125, v121, s88, v4
    v_fma_f32 v126, v122, s88, v4
    v_fma_f32 v127, v123, s88, v4
    v_exp_f32 v124, v124
    v_exp_f32 v125, v125
    v_exp_f32 v126, v126
    v_exp_f32 v127, v127
    v_pk_mul_f32 v[104:105], v[104:105], v[2:3] op_sel_hi:[1,0]
    v_pk_mul_f32 v[106:107], v[106:107], v[2:3] op_sel_hi:[1,0]
    v_pk_mul_f32 v[108:109], v[108:109], v[2:3] op_sel_hi:[1,0]
    v_pk_mul_f32 v[110:111], v[110:111], v[2:3] op_sel_hi:[1,0]
    v_fma_f32 v117, v117, v2, v124
    v_add_f32 v3, v125, v126
    v_add_f32 v117, v117, v127
    v_add_f32 v117, v117, v3
    s_waitcnt vmcnt(8)
    v_lshlrev_b32 v8, 16, v32
    v_and_b32 v9, s86, v32
    v_lshlrev_b32 v10, 16, v33
    v_and_b32 v11, s86, v33
    v_lshlrev_b32 v12, 16, v34
    v_and_b32 v13, s86, v34
    v_lshlrev_b32 v14, 16, v35
    v_and_b32 v15, s86, v35
    buffer_load_dwordx4 v[32:35], v1, s[36:39], s81 offen offset:0 sc1 nt
    v_pk_fma_f32 v[104:105], v[8:9], v[124:125], v[104:105] op_sel_hi:[1,0,1]
    v_pk_fma_f32 v[106:107], v[10:11], v[124:125], v[106:107] op_sel_hi:[1,0,1]
    v_pk_fma_f32 v[108:109], v[12:13], v[124:125], v[108:109] op_sel_hi:[1,0,1]
    v_pk_fma_f32 v[110:111], v[14:15], v[124:125], v[110:111] op_sel_hi:[1,0,1]
    s_waitcnt vmcnt(8)
    v_lshlrev_b32 v8, 16, v36
    v_and_b32 v9, s86, v36
    v_lshlrev_b32 v10, 16, v37
    v_and_b32 v11, s86, v37
    v_lshlrev_b32 v12, 16, v38
    v_and_b32 v13, s86, v38
    v_lshlrev_b32 v14, 16, v39
    v_and_b32 v15, s86, v39
    buffer_load_dwordx4 v[36:39], v1, s[36:39], s81 offen offset:1024 sc1 nt
    v_pk_fma_f32 v[104:105], v[8:9], v[124:125], v[104:105] op_sel:[0,1,0] op_sel_hi:[1,1,1]
    v_pk_fma_f32 v[106:107], v[10:11], v[124:125], v[106:107] op_sel:[0,1,0] op_sel_hi:[1,1,1]
    v_pk_fma_f32 v[108:109], v[12:13], v[124:125], v[108:109] op_sel:[0,1,0] op_sel_hi:[1,1,1]
    v_pk_fma_f32 v[110:111], v[14:15], v[124:125], v[110:111] op_sel:[0,1,0] op_sel_hi:[1,1,1]
    s_waitcnt vmcnt(8)
    v_lshlrev_b32 v8, 16, v40
    v_and_b32 v9, s86, v40
    v_lshlrev_b32 v10, 16, v41
    v_and_b32 v11, s86, v41
    v_lshlrev_b32 v12, 16, v42
    v_and_b32 v13, s86, v42
    v_lshlrev_b32 v14, 16, v43
    v_and_b32 v15, s86, v43
    buffer_load_dwordx4 v[40:43], v1, s[36:39], s81 offen offset:2048 sc1 nt
    v_pk_fma_f32 v[104:105], v[8:9], v[126:127], v[104:105] op_sel_hi:[1,0,1]
    v_pk_fma_f32 v[106:107], v[10:11], v[126:127], v[106:107] op_sel_hi:[1,0,1]
    v_pk_fma_f32 v[108:109], v[12:13], v[126:127], v[108:109] op_sel_hi:[1,0,1]
    v_pk_fma_f32 v[110:111], v[14:15], v[126:127], v[110:111] op_sel_hi:[1,0,1]
    s_waitcnt vmcnt(8)
    v_lshlrev_b32 v8, 16, v44
    v_and_b32 v9, s86, v44
    v_lshlrev_b32 v10, 16, v45
    v_and_b32 v11, s86, v45
    v_lshlrev_b32 v12, 16, v46
    v_and_b32 v13, s86, v46
    v_lshlrev_b32 v14, 16, v47
    v_and_b32 v15, s86, v47
    buffer_load_dwordx4 v[44:47], v1, s[36:39], s81 offen offset:3072 sc1 nt
    v_pk_fma_f32 v[104:105], v[8:9], v[126:127], v[104:105] op_sel:[0,1,0] op_sel_hi:[1,1,1]
    v_pk_fma_f32 v[106:107], v[10:11], v[126:127], v[106:107] op_sel:[0,1,0] op_sel_hi:[1,1,1]
    v_pk_fma_f32 v[108:109], v[12:13], v[126:127], v[108:109] op_sel:[0,1,0] op_sel_hi:[1,1,1]
    v_pk_fma_f32 v[110:111], v[14:15], v[126:127], v[110:111] op_sel:[0,1,0] op_sel_hi:[1,1,1]
    s_waitcnt vmcnt(47)
    v_and_b32 v120, s87, v118
    v_lshlrev_b32 v121, 16, v118
    v_dot2_f32_bf16 v8, v80, v120, 0
    v_dot2_f32_bf16 v9, v80, v121, 0
    v_dot2_f32_bf16 v10, v81, v120, 0
    v_dot2_f32_bf16 v11, v81, v121, 0
    v_dot2_f32_bf16 v12, v82, v120, 0
    v_dot2_f32_bf16 v13, v82, v121, 0
    v_dot2_f32_bf16 v14, v83, v120, 0
    v_dot2_f32_bf16 v15, v83, v121, 0
    s_waitcnt vmcnt(46)
    v_lshrrev_b32 v122, 16, v118
    v_and_b32 v123, s86, v118
    v_dot2_f32_bf16 v8, v84, v122, v8
    v_dot2_f32_bf16 v9, v84, v123, v9
    v_dot2_f32_bf16 v10, v85, v122, v10
    v_dot2_f32_bf16 v11, v85, v123, v11
    v_dot2_f32_bf16 v12, v86, v122, v12
    v_dot2_f32_bf16 v13, v86, v123, v13
    v_dot2_f32_bf16 v14, v87, v122, v14
    v_dot2_f32_bf16 v15, v87, v123, v15
    s_waitcnt vmcnt(37)
    v_and_b32 v120, s87, v119
    v_lshlrev_b32 v121, 16, v119
    v_dot2_f32_bf16 v8, v88, v120, v8
    v_dot2_f32_bf16 v9, v88, v121, v9
    v_dot2_f32_bf16 v10, v89, v120, v10
    v_dot2_f32_bf16 v11, v89, v121, v11
    v_dot2_f32_bf16 v12, v90, v120, v12
    v_dot2_f32_bf16 v13, v90, v121, v13
    v_dot2_f32_bf16 v14, v91, v120, v14
    v_dot2_f32_bf16 v15, v91, v121, v15
    s_waitcnt vmcnt(36)
    v_lshrrev_b32 v122, 16, v119
    v_and_b32 v123, s86, v119
    v_dot2_f32_bf16 v8, v92, v122, v8
    v_dot2_f32_bf16 v9, v92, v123, v9
    v_dot2_f32_bf16 v10, v93, v122, v10
    v_dot2_f32_bf16 v11, v93, v123, v11
    v_dot2_f32_bf16 v12, v94, v122, v12
    v_dot2_f32_bf16 v13, v94, v123, v13
    v_dot2_f32_bf16 v14, v95, v122, v14
    v_dot2_f32_bf16 v15, v95, v123, v15
    v_permlane32_swap_b32 v8, v12
    v_permlane32_swap_b32 v9, v13
    v_permlane32_swap_b32 v10, v14
    v_permlane32_swap_b32 v11, v15
    v_add_f32 v8, v8, v12
    v_add_f32 v9, v9, v13
    v_add_f32 v10, v10, v14
    v_add_f32 v11, v11, v15
    s_nop 0
    v_permlane16_swap_b32 v8, v10
    v_permlane16_swap_b32 v9, v11
    v_add_f32 v8, v8, v10
    v_add_f32 v9, v9, v11
    v_bfe_u32 v120, v1, 4, 2
    v_lshlrev_b32 v120, 5, v120
    v_lshl_add_u32 v120, v5, 3, v120
    s_mul_i32 s97, s3, 136
    v_add_u32 v120, s97, v120
    v_add_f32_dpp v8, v8, v8 row_ror:4 row_mask:0xf bank_mask:0xf
    v_add_f32_dpp v9, v9, v9 row_ror:4 row_mask:0xf bank_mask:0xf
    s_nop 0
    v_add_f32_dpp v8, v8, v8 row_ror:8 row_mask:0xf bank_mask:0xf
    v_add_f32_dpp v9, v9, v9 row_ror:8 row_mask:0xf bank_mask:0xf
    ds_write_b64 v120, v[8:9] offset:8448
    s_waitcnt vmcnt(18)
    v_lshlrev_b32 v80, 16, v96
    v_and_b32 v81, s86, v96
    v_lshlrev_b32 v82, 16, v97
    v_and_b32 v83, s86, v97
    v_lshlrev_b32 v84, 16, v98
    v_and_b32 v85, s86, v98
    v_lshlrev_b32 v86, 16, v99
    v_and_b32 v87, s86, v99
    v_lshlrev_b32 v88, 16, v100
    v_and_b32 v89, s86, v100
    v_lshlrev_b32 v90, 16, v101
    v_and_b32 v91, s86, v101
    v_lshlrev_b32 v92, 16, v102
    v_and_b32 v93, s86, v102
    v_lshlrev_b32 v94, 16, v103
    v_and_b32 v95, s86, v103
    s_waitcnt lgkmcnt(0)
    buffer_load_dwordx4 v[56:59], v1, s[44:47], s98 offen offset:2048
    buffer_load_dwordx4 v[60:63], v1, s[44:47], s98 offen offset:3072
    s_add_u32 s81, s81, 0x10000
    s_waitcnt vmcnt(9)
    v_dot2_f32_bf16 v120, v16, v112, 0
    v_dot2_f32_bf16 v120, v17, v113, v120
    v_dot2_f32_bf16 v120, v18, v114, v120
    v_dot2_f32_bf16 v120, v19, v115, v120
    buffer_load_dwordx4 v[16:19], v1, s[32:35], s81 offen offset:0 sc1 nt
    s_waitcnt vmcnt(9)
    v_dot2_f32_bf16 v121, v20, v112, 0
    v_dot2_f32_bf16 v121, v21, v113, v121
    v_dot2_f32_bf16 v121, v22, v114, v121
    v_dot2_f32_bf16 v121, v23, v115, v121
    buffer_load_dwordx4 v[20:23], v1, s[32:35], s81 offen offset:1024 sc1 nt
    s_waitcnt vmcnt(9)
    v_dot2_f32_bf16 v122, v24, v112, 0
    v_dot2_f32_bf16 v122, v25, v113, v122
    v_dot2_f32_bf16 v122, v26, v114, v122
    v_dot2_f32_bf16 v122, v27, v115, v122
    buffer_load_dwordx4 v[24:27], v1, s[32:35], s81 offen offset:2048 sc1 nt
    s_waitcnt vmcnt(9)
    v_dot2_f32_bf16 v123, v28, v112, 0
    v_dot2_f32_bf16 v123, v29, v113, v123
    v_dot2_f32_bf16 v123, v30, v114, v123
    v_dot2_f32_bf16 v123, v31, v115, v123
    buffer_load_dwordx4 v[28:31], v1, s[32:35], s81 offen offset:3072 sc1 nt
    v_add_f32_dpp v120, v120, v120 row_ror:8 row_mask:0xf bank_mask:0xf
    v_add_f32_dpp v121, v121, v121 row_ror:8 row_mask:0xf bank_mask:0xf
    v_add_f32_dpp v122, v122, v122 row_ror:8 row_mask:0xf bank_mask:0xf
    v_add_f32_dpp v123, v123, v123 row_ror:8 row_mask:0xf bank_mask:0xf
    v_add_f32_dpp v120, v120, v120 row_ror:4 row_mask:0xf bank_mask:0xf
    v_add_f32_dpp v121, v121, v121 row_ror:4 row_mask:0xf bank_mask:0xf
    v_add_f32_dpp v122, v122, v122 row_ror:4 row_mask:0xf bank_mask:0xf
    v_add_f32_dpp v123, v123, v123 row_ror:4 row_mask:0xf bank_mask:0xf
    v_add_f32_dpp v120, v120, v120 row_ror:2 row_mask:0xf bank_mask:0xf
    v_add_f32_dpp v121, v121, v121 row_ror:2 row_mask:0xf bank_mask:0xf
    v_add_f32_dpp v122, v122, v122 row_ror:2 row_mask:0xf bank_mask:0xf
    v_add_f32_dpp v123, v123, v123 row_ror:2 row_mask:0xf bank_mask:0xf
    v_add_f32_dpp v120, v120, v120 row_ror:1 row_mask:0xf bank_mask:0xf
    v_add_f32_dpp v121, v121, v121 row_ror:1 row_mask:0xf bank_mask:0xf
    v_add_f32_dpp v122, v122, v122 row_ror:1 row_mask:0xf bank_mask:0xf
    v_add_f32_dpp v123, v123, v123 row_ror:1 row_mask:0xf bank_mask:0xf
    v_max3_f32 v3, v120, v121, v116
    v_max3_f32 v3, v122, v123, v3
    v_sub_f32 v2, v116, v3
    v_mul_f32 v4, s89, v3
    v_mul_f32 v2, s88, v2
    v_mov_b32 v116, v3
    v_exp_f32 v2, v2
    v_fma_f32 v124, v120, s88, v4
    v_fma_f32 v125, v121, s88, v4
    v_fma_f32 v126, v122, s88, v4
    v_fma_f32 v127, v123, s88, v4
    v_exp_f32 v124, v124
    v_exp_f32 v125, v125
    v_exp_f32 v126, v126
    v_exp_f32 v127, v127
    v_pk_mul_f32 v[104:105], v[104:105], v[2:3] op_sel_hi:[1,0]
    v_pk_mul_f32 v[106:107], v[106:107], v[2:3] op_sel_hi:[1,0]
    v_pk_mul_f32 v[108:109], v[108:109], v[2:3] op_sel_hi:[1,0]
    v_pk_mul_f32 v[110:111], v[110:111], v[2:3] op_sel_hi:[1,0]
    v_fma_f32 v117, v117, v2, v124
    v_add_f32 v3, v125, v126
    v_add_f32 v117, v117, v127
    v_add_f32 v117, v117, v3
    s_waitcnt vmcnt(9)
    v_lshlrev_b32 v8, 16, v32
    v_and_b32 v9, s86, v32
    v_lshlrev_b32 v10, 16, v33
    v_and_b32 v11, s86, v33
    v_lshlrev_b32 v12, 16, v34
    v_and_b32 v13, s86, v34
    v_lshlrev_b32 v14, 16, v35
    v_and_b32 v15, s86, v35
    buffer_load_dwordx4 v[32:35], v1, s[36:39], s81 offen offset:0 sc1 nt
    v_pk_fma_f32 v[104:105], v[8:9], v[124:125], v[104:105] op_sel_hi:[1,0,1]
    v_pk_fma_f32 v[106:107], v[10:11], v[124:125], v[106:107] op_sel_hi:[1,0,1]
    v_pk_fma_f32 v[108:109], v[12:13], v[124:125], v[108:109] op_sel_hi:[1,0,1]
    v_pk_fma_f32 v[110:111], v[14:15], v[124:125], v[110:111] op_sel_hi:[1,0,1]
    s_waitcnt vmcnt(9)
    v_lshlrev_b32 v8, 16, v36
    v_and_b32 v9, s86, v36
    v_lshlrev_b32 v10, 16, v37
    v_and_b32 v11, s86, v37
    v_lshlrev_b32 v12, 16, v38
    v_and_b32 v13, s86, v38
    v_lshlrev_b32 v14, 16, v39
    v_and_b32 v15, s86, v39
    buffer_load_dwordx4 v[36:39], v1, s[36:39], s81 offen offset:1024 sc1 nt
    v_pk_fma_f32 v[104:105], v[8:9], v[124:125], v[104:105] op_sel:[0,1,0] op_sel_hi:[1,1,1]
    v_pk_fma_f32 v[106:107], v[10:11], v[124:125], v[106:107] op_sel:[0,1,0] op_sel_hi:[1,1,1]
    v_pk_fma_f32 v[108:109], v[12:13], v[124:125], v[108:109] op_sel:[0,1,0] op_sel_hi:[1,1,1]
    v_pk_fma_f32 v[110:111], v[14:15], v[124:125], v[110:111] op_sel:[0,1,0] op_sel_hi:[1,1,1]
    s_waitcnt vmcnt(9)
    v_lshlrev_b32 v8, 16, v40
    v_and_b32 v9, s86, v40
    v_lshlrev_b32 v10, 16, v41
    v_and_b32 v11, s86, v41
    v_lshlrev_b32 v12, 16, v42
    v_and_b32 v13, s86, v42
    v_lshlrev_b32 v14, 16, v43
    v_and_b32 v15, s86, v43
    buffer_load_dwordx4 v[40:43], v1, s[36:39], s81 offen offset:2048 sc1 nt
    v_pk_fma_f32 v[104:105], v[8:9], v[126:127], v[104:105] op_sel_hi:[1,0,1]
    v_pk_fma_f32 v[106:107], v[10:11], v[126:127], v[106:107] op_sel_hi:[1,0,1]
    v_pk_fma_f32 v[108:109], v[12:13], v[126:127], v[108:109] op_sel_hi:[1,0,1]
    v_pk_fma_f32 v[110:111], v[14:15], v[126:127], v[110:111] op_sel_hi:[1,0,1]
    s_waitcnt vmcnt(9)
    v_lshlrev_b32 v8, 16, v44
    v_and_b32 v9, s86, v44
    v_lshlrev_b32 v10, 16, v45
    v_and_b32 v11, s86, v45
    v_lshlrev_b32 v12, 16, v46
    v_and_b32 v13, s86, v46
    v_lshlrev_b32 v14, 16, v47
    v_and_b32 v15, s86, v47
    buffer_load_dwordx4 v[44:47], v1, s[36:39], s81 offen offset:3072 sc1 nt
    v_pk_fma_f32 v[104:105], v[8:9], v[126:127], v[104:105] op_sel:[0,1,0] op_sel_hi:[1,1,1]
    v_pk_fma_f32 v[106:107], v[10:11], v[126:127], v[106:107] op_sel:[0,1,0] op_sel_hi:[1,1,1]
    v_pk_fma_f32 v[108:109], v[12:13], v[126:127], v[108:109] op_sel:[0,1,0] op_sel_hi:[1,1,1]
    v_pk_fma_f32 v[110:111], v[14:15], v[126:127], v[110:111] op_sel:[0,1,0] op_sel_hi:[1,1,1]
    buffer_load_dwordx4 v[64:67], v1, s[44:47], s99 offen offset:0
    s_setprio 1
    s_add_u32 s81, s81, 0x10000
    s_waitcnt vmcnt(8)
    v_dot2_f32_bf16 v120, v16, v112, 0
    v_dot2_f32_bf16 v120, v17, v113, v120
    v_dot2_f32_bf16 v120, v18, v114, v120
    v_dot2_f32_bf16 v120, v19, v115, v120
    buffer_load_dwordx4 v[16:19], v1, s[32:35], s81 offen offset:0 sc1 nt
    s_waitcnt vmcnt(8)
    v_dot2_f32_bf16 v121, v20, v112, 0
    v_dot2_f32_bf16 v121, v21, v113, v121
    v_dot2_f32_bf16 v121, v22, v114, v121
    v_dot2_f32_bf16 v121, v23, v115, v121
    buffer_load_dwordx4 v[20:23], v1, s[32:35], s81 offen offset:1024 sc1 nt
    s_waitcnt vmcnt(8)
    v_dot2_f32_bf16 v122, v24, v112, 0
    v_dot2_f32_bf16 v122, v25, v113, v122
    v_dot2_f32_bf16 v122, v26, v114, v122
    v_dot2_f32_bf16 v122, v27, v115, v122
    buffer_load_dwordx4 v[24:27], v1, s[32:35], s81 offen offset:2048 sc1 nt
    s_waitcnt vmcnt(8)
    v_dot2_f32_bf16 v123, v28, v112, 0
    v_dot2_f32_bf16 v123, v29, v113, v123
    v_dot2_f32_bf16 v123, v30, v114, v123
    v_dot2_f32_bf16 v123, v31, v115, v123
    buffer_load_dwordx4 v[28:31], v1, s[32:35], s81 offen offset:3072 sc1 nt
    v_add_f32_dpp v120, v120, v120 row_ror:8 row_mask:0xf bank_mask:0xf
    v_add_f32_dpp v121, v121, v121 row_ror:8 row_mask:0xf bank_mask:0xf
    v_add_f32_dpp v122, v122, v122 row_ror:8 row_mask:0xf bank_mask:0xf
    v_add_f32_dpp v123, v123, v123 row_ror:8 row_mask:0xf bank_mask:0xf
    v_add_f32_dpp v120, v120, v120 row_ror:4 row_mask:0xf bank_mask:0xf
    v_add_f32_dpp v121, v121, v121 row_ror:4 row_mask:0xf bank_mask:0xf
    v_add_f32_dpp v122, v122, v122 row_ror:4 row_mask:0xf bank_mask:0xf
    v_add_f32_dpp v123, v123, v123 row_ror:4 row_mask:0xf bank_mask:0xf
    v_add_f32_dpp v120, v120, v120 row_ror:2 row_mask:0xf bank_mask:0xf
    v_add_f32_dpp v121, v121, v121 row_ror:2 row_mask:0xf bank_mask:0xf
    v_add_f32_dpp v122, v122, v122 row_ror:2 row_mask:0xf bank_mask:0xf
    v_add_f32_dpp v123, v123, v123 row_ror:2 row_mask:0xf bank_mask:0xf
    v_add_f32_dpp v120, v120, v120 row_ror:1 row_mask:0xf bank_mask:0xf
    v_add_f32_dpp v121, v121, v121 row_ror:1 row_mask:0xf bank_mask:0xf
    v_add_f32_dpp v122, v122, v122 row_ror:1 row_mask:0xf bank_mask:0xf
    v_add_f32_dpp v123, v123, v123 row_ror:1 row_mask:0xf bank_mask:0xf
    v_max3_f32 v3, v120, v121, v116
    v_max3_f32 v3, v122, v123, v3
    v_sub_f32 v2, v116, v3
    v_mul_f32 v4, s89, v3
    v_mul_f32 v2, s88, v2
    v_mov_b32 v116, v3
    v_exp_f32 v2, v2
    v_fma_f32 v124, v120, s88, v4
    v_fma_f32 v125, v121, s88, v4
    v_fma_f32 v126, v122, s88, v4
    v_fma_f32 v127, v123, s88, v4
    v_exp_f32 v124, v124
    v_exp_f32 v125, v125
    v_exp_f32 v126, v126
    v_exp_f32 v127, v127
    v_pk_mul_f32 v[104:105], v[104:105], v[2:3] op_sel_hi:[1,0]
    v_pk_mul_f32 v[106:107], v[106:107], v[2:3] op_sel_hi:[1,0]
    v_pk_mul_f32 v[108:109], v[108:109], v[2:3] op_sel_hi:[1,0]
    v_pk_mul_f32 v[110:111], v[110:111], v[2:3] op_sel_hi:[1,0]
    v_fma_f32 v117, v117, v2, v124
    v_add_f32 v3, v125, v126
    v_add_f32 v117, v117, v127
    v_add_f32 v117, v117, v3
    s_waitcnt vmcnt(8)
    v_lshlrev_b32 v8, 16, v32
    v_and_b32 v9, s86, v32
    v_lshlrev_b32 v10, 16, v33
    v_and_b32 v11, s86, v33
    v_lshlrev_b32 v12, 16, v34
    v_and_b32 v13, s86, v34
    v_lshlrev_b32 v14, 16, v35
    v_and_b32 v15, s86, v35
    buffer_load_dwordx4 v[32:35], v1, s[36:39], s81 offen offset:0 sc1 nt
    v_pk_fma_f32 v[104:105], v[8:9], v[124:125], v[104:105] op_sel_hi:[1,0,1]
    v_pk_fma_f32 v[106:107], v[10:11], v[124:125], v[106:107] op_sel_hi:[1,0,1]
    v_pk_fma_f32 v[108:109], v[12:13], v[124:125], v[108:109] op_sel_hi:[1,0,1]
    v_pk_fma_f32 v[110:111], v[14:15], v[124:125], v[110:111] op_sel_hi:[1,0,1]
    s_waitcnt vmcnt(8)
    v_lshlrev_b32 v8, 16, v36
    v_and_b32 v9, s86, v36
    v_lshlrev_b32 v10, 16, v37
    v_and_b32 v11, s86, v37
    v_lshlrev_b32 v12, 16, v38
    v_and_b32 v13, s86, v38
    v_lshlrev_b32 v14, 16, v39
    v_and_b32 v15, s86, v39
    buffer_load_dwordx4 v[36:39], v1, s[36:39], s81 offen offset:1024 sc1 nt
    v_pk_fma_f32 v[104:105], v[8:9], v[124:125], v[104:105] op_sel:[0,1,0] op_sel_hi:[1,1,1]
    v_pk_fma_f32 v[106:107], v[10:11], v[124:125], v[106:107] op_sel:[0,1,0] op_sel_hi:[1,1,1]
    v_pk_fma_f32 v[108:109], v[12:13], v[124:125], v[108:109] op_sel:[0,1,0] op_sel_hi:[1,1,1]
    v_pk_fma_f32 v[110:111], v[14:15], v[124:125], v[110:111] op_sel:[0,1,0] op_sel_hi:[1,1,1]
    s_waitcnt vmcnt(8)
    v_lshlrev_b32 v8, 16, v40
    v_and_b32 v9, s86, v40
    v_lshlrev_b32 v10, 16, v41
    v_and_b32 v11, s86, v41
    v_lshlrev_b32 v12, 16, v42
    v_and_b32 v13, s86, v42
    v_lshlrev_b32 v14, 16, v43
    v_and_b32 v15, s86, v43
    buffer_load_dwordx4 v[40:43], v1, s[36:39], s81 offen offset:2048 sc1 nt
    v_pk_fma_f32 v[104:105], v[8:9], v[126:127], v[104:105] op_sel_hi:[1,0,1]
    v_pk_fma_f32 v[106:107], v[10:11], v[126:127], v[106:107] op_sel_hi:[1,0,1]
    v_pk_fma_f32 v[108:109], v[12:13], v[126:127], v[108:109] op_sel_hi:[1,0,1]
    v_pk_fma_f32 v[110:111], v[14:15], v[126:127], v[110:111] op_sel_hi:[1,0,1]
    s_waitcnt vmcnt(8)
    v_lshlrev_b32 v8, 16, v44
    v_and_b32 v9, s86, v44
    v_lshlrev_b32 v10, 16, v45
    v_and_b32 v11, s86, v45
    v_lshlrev_b32 v12, 16, v46
    v_and_b32 v13, s86, v46
    v_lshlrev_b32 v14, 16, v47
    v_and_b32 v15, s86, v47
    buffer_load_dwordx4 v[44:47], v1, s[36:39], s81 offen offset:3072 sc1 nt
    v_pk_fma_f32 v[104:105], v[8:9], v[126:127], v[104:105] op_sel:[0,1,0] op_sel_hi:[1,1,1]
    v_pk_fma_f32 v[106:107], v[10:11], v[126:127], v[106:107] op_sel:[0,1,0] op_sel_hi:[1,1,1]
    v_pk_fma_f32 v[108:109], v[12:13], v[126:127], v[108:109] op_sel:[0,1,0] op_sel_hi:[1,1,1]
    v_pk_fma_f32 v[110:111], v[14:15], v[126:127], v[110:111] op_sel:[0,1,0] op_sel_hi:[1,1,1]
    buffer_load_dwordx4 v[68:71], v1, s[44:47], s99 offen offset:1024
    buffer_load_dwordx4 v[72:75], v1, s[44:47], s99 offen offset:2048
    s_add_u32 s81, s81, 0x10000
    s_waitcnt vmcnt(9)
    v_dot2_f32_bf16 v120, v16, v112, 0
    v_dot2_f32_bf16 v120, v17, v113, v120
    v_dot2_f32_bf16 v120, v18, v114, v120
    v_dot2_f32_bf16 v120, v19, v115, v120
    buffer_load_dwordx4 v[16:19], v1, s[32:35], s81 offen offset:0 sc1 nt
    s_waitcnt vmcnt(9)
    v_dot2_f32_bf16 v121, v20, v112, 0
    v_dot2_f32_bf16 v121, v21, v113, v121
    v_dot2_f32_bf16 v121, v22, v114, v121
    v_dot2_f32_bf16 v121, v23, v115, v121
    buffer_load_dwordx4 v[20:23], v1, s[32:35], s81 offen offset:1024 sc1 nt
    s_waitcnt vmcnt(9)
    v_dot2_f32_bf16 v122, v24, v112, 0
    v_dot2_f32_bf16 v122, v25, v113, v122
    v_dot2_f32_bf16 v122, v26, v114, v122
    v_dot2_f32_bf16 v122, v27, v115, v122
    buffer_load_dwordx4 v[24:27], v1, s[32:35], s81 offen offset:2048 sc1 nt
    s_waitcnt vmcnt(9)
    v_dot2_f32_bf16 v123, v28, v112, 0
    v_dot2_f32_bf16 v123, v29, v113, v123
    v_dot2_f32_bf16 v123, v30, v114, v123
    v_dot2_f32_bf16 v123, v31, v115, v123
    buffer_load_dwordx4 v[28:31], v1, s[32:35], s81 offen offset:3072 sc1 nt
    v_add_f32_dpp v120, v120, v120 row_ror:8 row_mask:0xf bank_mask:0xf
    v_add_f32_dpp v121, v121, v121 row_ror:8 row_mask:0xf bank_mask:0xf
    v_add_f32_dpp v122, v122, v122 row_ror:8 row_mask:0xf bank_mask:0xf
    v_add_f32_dpp v123, v123, v123 row_ror:8 row_mask:0xf bank_mask:0xf
    v_add_f32_dpp v120, v120, v120 row_ror:4 row_mask:0xf bank_mask:0xf
    v_add_f32_dpp v121, v121, v121 row_ror:4 row_mask:0xf bank_mask:0xf
    v_add_f32_dpp v122, v122, v122 row_ror:4 row_mask:0xf bank_mask:0xf
    v_add_f32_dpp v123, v123, v123 row_ror:4 row_mask:0xf bank_mask:0xf
    v_add_f32_dpp v120, v120, v120 row_ror:2 row_mask:0xf bank_mask:0xf
    v_add_f32_dpp v121, v121, v121 row_ror:2 row_mask:0xf bank_mask:0xf
    v_add_f32_dpp v122, v122, v122 row_ror:2 row_mask:0xf bank_mask:0xf
    v_add_f32_dpp v123, v123, v123 row_ror:2 row_mask:0xf bank_mask:0xf
    v_add_f32_dpp v120, v120, v120 row_ror:1 row_mask:0xf bank_mask:0xf
    v_add_f32_dpp v121, v121, v121 row_ror:1 row_mask:0xf bank_mask:0xf
    v_add_f32_dpp v122, v122, v122 row_ror:1 row_mask:0xf bank_mask:0xf
    v_add_f32_dpp v123, v123, v123 row_ror:1 row_mask:0xf bank_mask:0xf
    v_max3_f32 v3, v120, v121, v116
    v_max3_f32 v3, v122, v123, v3
    v_sub_f32 v2, v116, v3
    v_mul_f32 v4, s89, v3
    v_mul_f32 v2, s88, v2
    v_mov_b32 v116, v3
    v_exp_f32 v2, v2
    v_fma_f32 v124, v120, s88, v4
    v_fma_f32 v125, v121, s88, v4
    v_fma_f32 v126, v122, s88, v4
    v_fma_f32 v127, v123, s88, v4
    v_exp_f32 v124, v124
    v_exp_f32 v125, v125
    v_exp_f32 v126, v126
    v_exp_f32 v127, v127
    v_pk_mul_f32 v[104:105], v[104:105], v[2:3] op_sel_hi:[1,0]
    v_pk_mul_f32 v[106:107], v[106:107], v[2:3] op_sel_hi:[1,0]
    v_pk_mul_f32 v[108:109], v[108:109], v[2:3] op_sel_hi:[1,0]
    v_pk_mul_f32 v[110:111], v[110:111], v[2:3] op_sel_hi:[1,0]
    v_fma_f32 v117, v117, v2, v124
    v_add_f32 v3, v125, v126
    v_add_f32 v117, v117, v127
    v_add_f32 v117, v117, v3
    s_waitcnt vmcnt(9)
    v_lshlrev_b32 v8, 16, v32
    v_and_b32 v9, s86, v32
    v_lshlrev_b32 v10, 16, v33
    v_and_b32 v11, s86, v33
    v_lshlrev_b32 v12, 16, v34
    v_and_b32 v13, s86, v34
    v_lshlrev_b32 v14, 16, v35
    v_and_b32 v15, s86, v35
    buffer_load_dwordx4 v[32:35], v1, s[36:39], s81 offen offset:0 sc1 nt
    v_pk_fma_f32 v[104:105], v[8:9], v[124:125], v[104:105] op_sel_hi:[1,0,1]
    v_pk_fma_f32 v[106:107], v[10:11], v[124:125], v[106:107] op_sel_hi:[1,0,1]
    v_pk_fma_f32 v[108:109], v[12:13], v[124:125], v[108:109] op_sel_hi:[1,0,1]
    v_pk_fma_f32 v[110:111], v[14:15], v[124:125], v[110:111] op_sel_hi:[1,0,1]
    s_waitcnt vmcnt(9)
    v_lshlrev_b32 v8, 16, v36
    v_and_b32 v9, s86, v36
    v_lshlrev_b32 v10, 16, v37
    v_and_b32 v11, s86, v37
    v_lshlrev_b32 v12, 16, v38
    v_and_b32 v13, s86, v38
    v_lshlrev_b32 v14, 16, v39
    v_and_b32 v15, s86, v39
    buffer_load_dwordx4 v[36:39], v1, s[36:39], s81 offen offset:1024 sc1 nt
    v_pk_fma_f32 v[104:105], v[8:9], v[124:125], v[104:105] op_sel:[0,1,0] op_sel_hi:[1,1,1]
    v_pk_fma_f32 v[106:107], v[10:11], v[124:125], v[106:107] op_sel:[0,1,0] op_sel_hi:[1,1,1]
    v_pk_fma_f32 v[108:109], v[12:13], v[124:125], v[108:109] op_sel:[0,1,0] op_sel_hi:[1,1,1]
    v_pk_fma_f32 v[110:111], v[14:15], v[124:125], v[110:111] op_sel:[0,1,0] op_sel_hi:[1,1,1]
    s_waitcnt vmcnt(9)
    v_lshlrev_b32 v8, 16, v40
    v_and_b32 v9, s86, v40
    v_lshlrev_b32 v10, 16, v41
    v_and_b32 v11, s86, v41
    v_lshlrev_b32 v12, 16, v42
    v_and_b32 v13, s86, v42
    v_lshlrev_b32 v14, 16, v43
    v_and_b32 v15, s86, v43
    buffer_load_dwordx4 v[40:43], v1, s[36:39], s81 offen offset:2048 sc1 nt
    v_pk_fma_f32 v[104:105], v[8:9], v[126:127], v[104:105] op_sel_hi:[1,0,1]
    v_pk_fma_f32 v[106:107], v[10:11], v[126:127], v[106:107] op_sel_hi:[1,0,1]
    v_pk_fma_f32 v[108:109], v[12:13], v[126:127], v[108:109] op_sel_hi:[1,0,1]
    v_pk_fma_f32 v[110:111], v[14:15], v[126:127], v[110:111] op_sel_hi:[1,0,1]
    s_waitcnt vmcnt(9)
    v_lshlrev_b32 v8, 16, v44
    v_and_b32 v9, s86, v44
    v_lshlrev_b32 v10, 16, v45
    v_and_b32 v11, s86, v45
    v_lshlrev_b32 v12, 16, v46
    v_and_b32 v13, s86, v46
    v_lshlrev_b32 v14, 16, v47
    v_and_b32 v15, s86, v47
    buffer_load_dwordx4 v[44:47], v1, s[36:39], s81 offen offset:3072 sc1 nt
    v_pk_fma_f32 v[104:105], v[8:9], v[126:127], v[104:105] op_sel:[0,1,0] op_sel_hi:[1,1,1]
    v_pk_fma_f32 v[106:107], v[10:11], v[126:127], v[106:107] op_sel:[0,1,0] op_sel_hi:[1,1,1]
    v_pk_fma_f32 v[108:109], v[12:13], v[126:127], v[108:109] op_sel:[0,1,0] op_sel_hi:[1,1,1]
    v_pk_fma_f32 v[110:111], v[14:15], v[126:127], v[110:111] op_sel:[0,1,0] op_sel_hi:[1,1,1]
    buffer_load_dwordx4 v[76:79], v1, s[44:47], s99 offen offset:3072
    s_add_u32 s81, s81, 0x10000
    s_waitcnt vmcnt(8)
    v_dot2_f32_bf16 v120, v16, v112, 0
    v_dot2_f32_bf16 v120, v17, v113, v120
    v_dot2_f32_bf16 v120, v18, v114, v120
    v_dot2_f32_bf16 v120, v19, v115, v120
    buffer_load_dwordx4 v[16:19], v1, s[32:35], s81 offen offset:0 sc1 nt
    s_waitcnt vmcnt(8)
    v_dot2_f32_bf16 v121, v20, v112, 0
    v_dot2_f32_bf16 v121, v21, v113, v121
    v_dot2_f32_bf16 v121, v22, v114, v121
    v_dot2_f32_bf16 v121, v23, v115, v121
    buffer_load_dwordx4 v[20:23], v1, s[32:35], s81 offen offset:1024 sc1 nt
    s_waitcnt vmcnt(8)
    v_dot2_f32_bf16 v122, v24, v112, 0
    v_dot2_f32_bf16 v122, v25, v113, v122
    v_dot2_f32_bf16 v122, v26, v114, v122
    v_dot2_f32_bf16 v122, v27, v115, v122
    buffer_load_dwordx4 v[24:27], v1, s[32:35], s81 offen offset:2048 sc1 nt
    s_waitcnt vmcnt(8)
    v_dot2_f32_bf16 v123, v28, v112, 0
    v_dot2_f32_bf16 v123, v29, v113, v123
    v_dot2_f32_bf16 v123, v30, v114, v123
    v_dot2_f32_bf16 v123, v31, v115, v123
    buffer_load_dwordx4 v[28:31], v1, s[32:35], s81 offen offset:3072 sc1 nt
    v_add_f32_dpp v120, v120, v120 row_ror:8 row_mask:0xf bank_mask:0xf
    v_add_f32_dpp v121, v121, v121 row_ror:8 row_mask:0xf bank_mask:0xf
    v_add_f32_dpp v122, v122, v122 row_ror:8 row_mask:0xf bank_mask:0xf
    v_add_f32_dpp v123, v123, v123 row_ror:8 row_mask:0xf bank_mask:0xf
    v_add_f32_dpp v120, v120, v120 row_ror:4 row_mask:0xf bank_mask:0xf
    v_add_f32_dpp v121, v121, v121 row_ror:4 row_mask:0xf bank_mask:0xf
    v_add_f32_dpp v122, v122, v122 row_ror:4 row_mask:0xf bank_mask:0xf
    v_add_f32_dpp v123, v123, v123 row_ror:4 row_mask:0xf bank_mask:0xf
    v_add_f32_dpp v120, v120, v120 row_ror:2 row_mask:0xf bank_mask:0xf
    v_add_f32_dpp v121, v121, v121 row_ror:2 row_mask:0xf bank_mask:0xf
    v_add_f32_dpp v122, v122, v122 row_ror:2 row_mask:0xf bank_mask:0xf
    v_add_f32_dpp v123, v123, v123 row_ror:2 row_mask:0xf bank_mask:0xf
    v_add_f32_dpp v120, v120, v120 row_ror:1 row_mask:0xf bank_mask:0xf
    v_add_f32_dpp v121, v121, v121 row_ror:1 row_mask:0xf bank_mask:0xf
    v_add_f32_dpp v122, v122, v122 row_ror:1 row_mask:0xf bank_mask:0xf
    v_add_f32_dpp v123, v123, v123 row_ror:1 row_mask:0xf bank_mask:0xf
    v_max3_f32 v3, v120, v121, v116
    v_max3_f32 v3, v122, v123, v3
    v_sub_f32 v2, v116, v3
    v_mul_f32 v4, s89, v3
    v_mul_f32 v2, s88, v2
    v_mov_b32 v116, v3
    v_exp_f32 v2, v2
    v_fma_f32 v124, v120, s88, v4
    v_fma_f32 v125, v121, s88, v4
    v_fma_f32 v126, v122, s88, v4
    v_fma_f32 v127, v123, s88, v4
    v_exp_f32 v124, v124
    v_exp_f32 v125, v125
    v_exp_f32 v126, v126
    v_exp_f32 v127, v127
    v_pk_mul_f32 v[104:105], v[104:105], v[2:3] op_sel_hi:[1,0]
    v_pk_mul_f32 v[106:107], v[106:107], v[2:3] op_sel_hi:[1,0]
    v_pk_mul_f32 v[108:109], v[108:109], v[2:3] op_sel_hi:[1,0]
    v_pk_mul_f32 v[110:111], v[110:111], v[2:3] op_sel_hi:[1,0]
    v_fma_f32 v117, v117, v2, v124
    v_add_f32 v3, v125, v126
    v_add_f32 v117, v117, v127
    v_add_f32 v117, v117, v3
    v_mov_b32 v0, 0x100000
    s_cmp_eq_u32 s3, 0
    s_cbranch_scc1 L_noclaimA
    s_mov_b64 exec, 1
    ds_add_rtn_u32 v0, v1, v7 offset:12416
    s_mov_b64 exec, -1
L_noclaimA:
    s_waitcnt vmcnt(8)
    v_lshlrev_b32 v8, 16, v32
    v_and_b32 v9, s86, v32
    v_lshlrev_b32 v10, 16, v33
    v_and_b32 v11, s86, v33
    v_lshlrev_b32 v12, 16, v34
    v_and_b32 v13, s86, v34
    v_lshlrev_b32 v14, 16, v35
    v_and_b32 v15, s86, v35
    buffer_load_dwordx4 v[32:35], v1, s[36:39], s81 offen offset:0 sc1 nt
    v_pk_fma_f32 v[104:105], v[8:9], v[124:125], v[104:105] op_sel_hi:[1,0,1]
    v_pk_fma_f32 v[106:107], v[10:11], v[124:125], v[106:107] op_sel_hi:[1,0,1]
    v_pk_fma_f32 v[108:109], v[12:13], v[124:125], v[108:109] op_sel_hi:[1,0,1]
    v_pk_fma_f32 v[110:111], v[14:15], v[124:125], v[110:111] op_sel_hi:[1,0,1]
    s_waitcnt vmcnt(8)
    v_lshlrev_b32 v8, 16, v36
    v_and_b32 v9, s86, v36
    v_lshlrev_b32 v10, 16, v37
    v_and_b32 v11, s86, v37
    v_lshlrev_b32 v12, 16, v38
    v_and_b32 v13, s86, v38
    v_lshlrev_b32 v14, 16, v39
    v_and_b32 v15, s86, v39
    buffer_load_dwordx4 v[36:39], v1, s[36:39], s81 offen offset:1024 sc1 nt
    v_pk_fma_f32 v[104:105], v[8:9], v[124:125], v[104:105] op_sel:[0,1,0] op_sel_hi:[1,1,1]
    v_pk_fma_f32 v[106:107], v[10:11], v[124:125], v[106:107] op_sel:[0,1,0] op_sel_hi:[1,1,1]
    v_pk_fma_f32 v[108:109], v[12:13], v[124:125], v[108:109] op_sel:[0,1,0] op_sel_hi:[1,1,1]
    v_pk_fma_f32 v[110:111], v[14:15], v[124:125], v[110:111] op_sel:[0,1,0] op_sel_hi:[1,1,1]
    s_waitcnt vmcnt(8)
    v_lshlrev_b32 v8, 16, v40
    v_and_b32 v9, s86, v40
    v_lshlrev_b32 v10, 16, v41
    v_and_b32 v11, s86, v41
    v_lshlrev_b32 v12, 16, v42
    v_and_b32 v13, s86, v42
    v_lshlrev_b32 v14, 16, v43
    v_and_b32 v15, s86, v43
    buffer_load_dwordx4 v[40:43], v1, s[36:39], s81 offen offset:2048 sc1 nt
    v_pk_fma_f32 v[104:105], v[8:9], v[126:127], v[104:105] op_sel_hi:[1,0,1]
    v_pk_fma_f32 v[106:107], v[10:11], v[126:127], v[106:107] op_sel_hi:[1,0,1]
    v_pk_fma_f32 v[108:109], v[12:13], v[126:127], v[108:109] op_sel_hi:[1,0,1]
    v_pk_fma_f32 v[110:111], v[14:15], v[126:127], v[110:111] op_sel_hi:[1,0,1]
    s_waitcnt vmcnt(8)
    v_lshlrev_b32 v8, 16, v44
    v_and_b32 v9, s86, v44
    v_lshlrev_b32 v10, 16, v45
    v_and_b32 v11, s86, v45
    v_lshlrev_b32 v12, 16, v46
    v_and_b32 v13, s86, v46
    v_lshlrev_b32 v14, 16, v47
    v_and_b32 v15, s86, v47
    buffer_load_dwordx4 v[44:47], v1, s[36:39], s81 offen offset:3072 sc1 nt
    v_pk_fma_f32 v[104:105], v[8:9], v[126:127], v[104:105] op_sel:[0,1,0] op_sel_hi:[1,1,1]
    v_pk_fma_f32 v[106:107], v[10:11], v[126:127], v[106:107] op_sel:[0,1,0] op_sel_hi:[1,1,1]
    v_pk_fma_f32 v[108:109], v[12:13], v[126:127], v[108:109] op_sel:[0,1,0] op_sel_hi:[1,1,1]
    v_pk_fma_f32 v[110:111], v[14:15], v[126:127], v[110:111] op_sel:[0,1,0] op_sel_hi:[1,1,1]
    s_setprio 0
L_loopA:
    s_waitcnt lgkmcnt(0)
    v_readfirstlane_b32 s81, v0
    s_cmp_ge_u32 s81, 0x100000
    s_cbranch_scc1 L_lastA
    s_waitcnt vmcnt(7)
    v_dot2_f32_bf16 v120, v16, v112, 0
    v_dot2_f32_bf16 v120, v17, v113, v120
    v_dot2_f32_bf16 v120, v18, v114, v120
    v_dot2_f32_bf16 v120, v19, v115, v120
    buffer_load_dwordx4 v[16:19], v1, s[32:35], s81 offen offset:0 sc1 nt
    s_waitcnt vmcnt(7)
    v_dot2_f32_bf16 v121, v20, v112, 0
    v_dot2_f32_bf16 v121, v21, v113, v121
    v_dot2_f32_bf16 v121, v22, v114, v121
    v_dot2_f32_bf16 v121, v23, v115, v121
    buffer_load_dwordx4 v[20:23], v1, s[32:35], s81 offen offset:1024 sc1 nt
    s_waitcnt vmcnt(7)
    v_dot2_f32_bf16 v122, v24, v112, 0
    v_dot2_f32_bf16 v122, v25, v113, v122
    v_dot2_f32_bf16 v122, v26, v114, v122
    v_dot2_f32_bf16 v122, v27, v115, v122
    buffer_load_dwordx4 v[24:27], v1, s[32:35], s81 offen offset:2048 sc1 nt
    s_waitcnt vmcnt(7)
    v_dot2_f32_bf16 v123, v28, v112, 0
    v_dot2_f32_bf16 v123, v29, v113, v123
    v_dot2_f32_bf16 v123, v30, v114, v123
    v_dot2_f32_bf16 v123, v31, v115, v123
    buffer_load_dwordx4 v[28:31], v1, s[32:35], s81 offen offset:3072 sc1 nt
    v_add_f32_dpp v120, v120, v120 row_ror:8 row_mask:0xf bank_mask:0xf
    v_add_f32_dpp v121, v121, v121 row_ror:8 row_mask:0xf bank_mask:0xf
    v_add_f32_dpp v122, v122, v122 row_ror:8 row_mask:0xf bank_mask:0xf
    v_add_f32_dpp v123, v123, v123 row_ror:8 row_mask:0xf bank_mask:0xf
    v_add_f32_dpp v120, v120, v120 row_ror:4 row_mask:0xf bank_mask:0xf
    v_add_f32_dpp v121, v121, v121 row_ror:4 row_mask:0xf bank_mask:0xf
    v_add_f32_dpp v122, v122, v122 row_ror:4 row_mask:0xf bank_mask:0xf
    v_add_f32_dpp v123, v123, v123 row_ror:4 row_mask:0xf bank_mask:0xf
    v_add_f32_dpp v120, v120, v120 row_ror:2 row_mask:0xf bank_mask:0xf
    v_add_f32_dpp v121, v121, v121 row_ror:2 row_mask:0xf bank_mask:0xf
    v_add_f32_dpp v122, v122, v122 row_ror:2 row_mask:0xf bank_mask:0xf
    v_add_f32_dpp v123, v123, v123 row_ror:2 row_mask:0xf bank_mask:0xf
    v_add_f32_dpp v120, v120, v120 row_ror:1 row_mask:0xf bank_mask:0xf
    v_add_f32_dpp v121, v121, v121 row_ror:1 row_mask:0xf bank_mask:0xf
    v_add_f32_dpp v122, v122, v122 row_ror:1 row_mask:0xf bank_mask:0xf
    v_add_f32_dpp v123, v123, v123 row_ror:1 row_mask:0xf bank_mask:0xf
    v_max3_f32 v3, v120, v121, v116
    v_max3_f32 v3, v122, v123, v3
    v_sub_f32 v2, v116, v3
    v_mul_f32 v4, s89, v3
    v_mul_f32 v2, s88, v2
    v_mov_b32 v116, v3
    v_exp_f32 v2, v2
    v_fma_f32 v124, v120, s88, v4
    v_fma_f32 v125, v121, s88, v4
    v_fma_f32 v126, v122, s88, v4
    v_fma_f32 v127, v123, s88, v4
    v_exp_f32 v124, v124
    v_exp_f32 v125, v125
    v_exp_f32 v126, v126
    v_exp_f32 v127, v127
    v_pk_mul_f32 v[104:105], v[104:105], v[2:3] op_sel_hi:[1,0]
    v_pk_mul_f32 v[106:107], v[106:107], v[2:3] op_sel_hi:[1,0]
    v_pk_mul_f32 v[108:109], v[108:109], v[2:3] op_sel_hi:[1,0]
    v_pk_mul_f32 v[110:111], v[110:111], v[2:3] op_sel_hi:[1,0]
    v_fma_f32 v117, v117, v2, v124
    v_add_f32 v3, v125, v126
    v_add_f32 v117, v117, v127
    v_add_f32 v117, v117, v3
    s_mov_b64 exec, 1
    ds_add_rtn_u32 v0, v1, v7 offset:12416
    s_mov_b64 exec, -1
    s_waitcnt vmcnt(7)
    v_lshlrev_b32 v8, 16, v32
    v_and_b32 v9, s86, v32
    v_lshlrev_b32 v10, 16, v33
    v_and_b32 v11, s86, v33
    v_lshlrev_b32 v12, 16, v34
    v_and_b32 v13, s86, v34
    v_lshlrev_b32 v14, 16, v35
    v_and_b32 v15, s86, v35
    buffer_load_dwordx4 v[32:35], v1, s[36:39], s81 offen offset:0 sc1 nt
    v_pk_fma_f32 v[104:105], v[8:9], v[124:125], v[104:105] op_sel_hi:[1,0,1]
    v_pk_fma_f32 v[106:107], v[10:11], v[124:125], v[106:107] op_sel_hi:[1,0,1]
    v_pk_fma_f32 v[108:109], v[12:13], v[124:125], v[108:109] op_sel_hi:[1,0,1]
    v_pk_fma_f32 v[110:111], v[14:15], v[124:125], v[110:111] op_sel_hi:[1,0,1]
    s_waitcnt vmcnt(7)
    v_lshlrev_b32 v8, 16, v36
    v_and_b32 v9, s86, v36
    v_lshlrev_b32 v10, 16, v37
    v_and_b32 v11, s86, v37
    v_lshlrev_b32 v12, 16, v38
    v_and_b32 v13, s86, v38
    v_lshlrev_b32 v14, 16, v39
    v_and_b32 v15, s86, v39
    buffer_load_dwordx4 v[36:39], v1, s[36:39], s81 offen offset:1024 sc1 nt
    v_pk_fma_f32 v[104:105], v[8:9], v[124:125], v[104:105] op_sel:[0,1,0] op_sel_hi:[1,1,1]
    v_pk_fma_f32 v[106:107], v[10:11], v[124:125], v[106:107] op_sel:[0,1,0] op_sel_hi:[1,1,1]
    v_pk_fma_f32 v[108:109], v[12:13], v[124:125], v[108:109] op_sel:[0,1,0] op_sel_hi:[1,1,1]
    v_pk_fma_f32 v[110:111], v[14:15], v[124:125], v[110:111] op_sel:[0,1,0] op_sel_hi:[1,1,1]
    s_waitcnt vmcnt(7)
    v_lshlrev_b32 v8, 16, v40
    v_and_b32 v9, s86, v40
    v_lshlrev_b32 v10, 16, v41
    v_and_b32 v11, s86, v41
    v_lshlrev_b32 v12, 16, v42
    v_and_b32 v13, s86, v42
    v_lshlrev_b32 v14, 16, v43
    v_and_b32 v15, s86, v43
    buffer_load_dwordx4 v[40:43], v1, s[36:39], s81 offen offset:2048 sc1 nt
    v_pk_fma_f32 v[104:105], v[8:9], v[126:127], v[104:105] op_sel_hi:[1,0,1]
    v_pk_fma_f32 v[106:107], v[10:11], v[126:127], v[106:107] op_sel_hi:[1,0,1]
    v_pk_fma_f32 v[108:109], v[12:13], v[126:127], v[108:109] op_sel_hi:[1,0,1]
    v_pk_fma_f32 v[110:111], v[14:15], v[126:127], v[110:111] op_sel_hi:[1,0,1]
    s_waitcnt vmcnt(7)
    v_lshlrev_b32 v8, 16, v44
    v_and_b32 v9, s86, v44
    v_lshlrev_b32 v10, 16, v45
    v_and_b32 v11, s86, v45
    v_lshlrev_b32 v12, 16, v46
    v_and_b32 v13, s86, v46
    v_lshlrev_b32 v14, 16, v47
    v_and_b32 v15, s86, v47
    buffer_load_dwordx4 v[44:47], v1, s[36:39], s81 offen offset:3072 sc1 nt
    v_pk_fma_f32 v[104:105], v[8:9], v[126:127], v[104:105] op_sel:[0,1,0] op_sel_hi:[1,1,1]
    v_pk_fma_f32 v[106:107], v[10:11], v[126:127], v[106:107] op_sel:[0,1,0] op_sel_hi:[1,1,1]
    v_pk_fma_f32 v[108:109], v[12:13], v[126:127], v[108:109] op_sel:[0,1,0] op_sel_hi:[1,1,1]
    v_pk_fma_f32 v[110:111], v[14:15], v[126:127], v[110:111] op_sel:[0,1,0] op_sel_hi:[1,1,1]
    s_branch L_loopA
L_lastA:
    s_waitcnt vmcnt(7)
    v_dot2_f32_bf16 v120, v16, v112, 0
    v_dot2_f32_bf16 v120, v17, v113, v120
    v_dot2_f32_bf16 v120, v18, v114, v120
    v_dot2_f32_bf16 v120, v19, v115, v120
    s_waitcnt vmcnt(6)
    v_dot2_f32_bf16 v121, v20, v112, 0
    v_dot2_f32_bf16 v121, v21, v113, v121
    v_dot2_f32_bf16 v121, v22, v114, v121
    v_dot2_f32_bf16 v121, v23, v115, v121
    s_waitcnt vmcnt(5)
    v_dot2_f32_bf16 v122, v24, v112, 0
    v_dot2_f32_bf16 v122, v25, v113, v122
    v_dot2_f32_bf16 v122, v26, v114, v122
    v_dot2_f32_bf16 v122, v27, v115, v122
    s_waitcnt vmcnt(4)
    v_dot2_f32_bf16 v123, v28, v112, 0
    v_dot2_f32_bf16 v123, v29, v113, v123
    v_dot2_f32_bf16 v123, v30, v114, v123
    v_dot2_f32_bf16 v123, v31, v115, v123
    v_add_f32_dpp v120, v120, v120 row_ror:8 row_mask:0xf bank_mask:0xf
    v_add_f32_dpp v121, v121, v121 row_ror:8 row_mask:0xf bank_mask:0xf
    v_add_f32_dpp v122, v122, v122 row_ror:8 row_mask:0xf bank_mask:0xf
    v_add_f32_dpp v123, v123, v123 row_ror:8 row_mask:0xf bank_mask:0xf
    v_add_f32_dpp v120, v120, v120 row_ror:4 row_mask:0xf bank_mask:0xf
    v_add_f32_dpp v121, v121, v121 row_ror:4 row_mask:0xf bank_mask:0xf
    v_add_f32_dpp v122, v122, v122 row_ror:4 row_mask:0xf bank_mask:0xf
    v_add_f32_dpp v123, v123, v123 row_ror:4 row_mask:0xf bank_mask:0xf
    v_add_f32_dpp v120, v120, v120 row_ror:2 row_mask:0xf bank_mask:0xf
    v_add_f32_dpp v121, v121, v121 row_ror:2 row_mask:0xf bank_mask:0xf
    v_add_f32_dpp v122, v122, v122 row_ror:2 row_mask:0xf bank_mask:0xf
    v_add_f32_dpp v123, v123, v123 row_ror:2 row_mask:0xf bank_mask:0xf
    v_add_f32_dpp v120, v120, v120 row_ror:1 row_mask:0xf bank_mask:0xf
    v_add_f32_dpp v121, v121, v121 row_ror:1 row_mask:0xf bank_mask:0xf
    v_add_f32_dpp v122, v122, v122 row_ror:1 row_mask:0xf bank_mask:0xf
    v_add_f32_dpp v123, v123, v123 row_ror:1 row_mask:0xf bank_mask:0xf
    v_max3_f32 v3, v120, v121, v116
    v_max3_f32 v3, v122, v123, v3
    v_sub_f32 v2, v116, v3
    v_mul_f32 v4, s89, v3
    v_mul_f32 v2, s88, v2
    v_mov_b32 v116, v3
    v_exp_f32 v2, v2
    v_fma_f32 v124, v120, s88, v4
    v_fma_f32 v125, v121, s88, v4
    v_fma_f32 v126, v122, s88, v4
    v_fma_f32 v127, v123, s88, v4
    v_exp_f32 v124, v124
    v_exp_f32 v125, v125
    v_exp_f32 v126, v126
    v_exp_f32 v127, v127
    v_pk_mul_f32 v[104:105], v[104:105], v[2:3] op_sel_hi:[1,0]
    v_pk_mul_f32 v[106:107], v[106:107], v[2:3] op_sel_hi:[1,0]
    v_pk_mul_f32 v[108:109], v[108:109], v[2:3] op_sel_hi:[1,0]
    v_pk_mul_f32 v[110:111], v[110:111], v[2:3] op_sel_hi:[1,0]
    v_fma_f32 v117, v117, v2, v124
    v_add_f32 v3, v125, v126
    v_add_f32 v117, v117, v127
    v_add_f32 v117, v117, v3
    s_waitcnt vmcnt(3)
    v_lshlrev_b32 v8, 16, v32
    v_and_b32 v9, s86, v32
    v_lshlrev_b32 v10, 16, v33
    v_and_b32 v11, s86, v33
    v_lshlrev_b32 v12, 16, v34
    v_and_b32 v13, s86, v34
    v_lshlrev_b32 v14, 16, v35
    v_and_b32 v15, s86, v35
    v_pk_fma_f32 v[104:105], v[8:9], v[124:125], v[104:105] op_sel_hi:[1,0,1]
    v_pk_fma_f32 v[106:107], v[10:11], v[124:125], v[106:107] op_sel_hi:[1,0,1]
    v_pk_fma_f32 v[108:109], v[12:13], v[124:125], v[108:109] op_sel_hi:[1,0,1]
    v_pk_fma_f32 v[110:111], v[14:15], v[124:125], v[110:111] op_sel_hi:[1,0,1]
    s_waitcnt vmcnt(2)
    v_lshlrev_b32 v8, 16, v36
    v_and_b32 v9, s86, v36
    v_lshlrev_b32 v10, 16, v37
    v_and_b32 v11, s86, v37
    v_lshlrev_b32 v12, 16, v38
    v_and_b32 v13, s86, v38
    v_lshlrev_b32 v14, 16, v39
    v_and_b32 v15, s86, v39
    v_pk_fma_f32 v[104:105], v[8:9], v[124:125], v[104:105] op_sel:[0,1,0] op_sel_hi:[1,1,1]
    v_pk_fma_f32 v[106:107], v[10:11], v[124:125], v[106:107] op_sel:[0,1,0] op_sel_hi:[1,1,1]
    v_pk_fma_f32 v[108:109], v[12:13], v[124:125], v[108:109] op_sel:[0,1,0] op_sel_hi:[1,1,1]
    v_pk_fma_f32 v[110:111], v[14:15], v[124:125], v[110:111] op_sel:[0,1,0] op_sel_hi:[1,1,1]
    s_waitcnt vmcnt(1)
    v_lshlrev_b32 v8, 16, v40
    v_and_b32 v9, s86, v40
    v_lshlrev_b32 v10, 16, v41
    v_and_b32 v11, s86, v41
    v_lshlrev_b32 v12, 16, v42
    v_and_b32 v13, s86, v42
    v_lshlrev_b32 v14, 16, v43
    v_and_b32 v15, s86, v43
    v_pk_fma_f32 v[104:105], v[8:9], v[126:127], v[104:105] op_sel_hi:[1,0,1]
    v_pk_fma_f32 v[106:107], v[10:11], v[126:127], v[106:107] op_sel_hi:[1,0,1]
    v_pk_fma_f32 v[108:109], v[12:13], v[126:127], v[108:109] op_sel_hi:[1,0,1]
    v_pk_fma_f32 v[110:111], v[14:15], v[126:127], v[110:111] op_sel_hi:[1,0,1]
    s_waitcnt vmcnt(0)
    v_lshlrev_b32 v8, 16, v44
    v_and_b32 v9, s86, v44
    v_lshlrev_b32 v10, 16, v45
    v_and_b32 v11, s86, v45
    v_lshlrev_b32 v12, 16, v46
    v_and_b32 v13, s86, v46
    v_lshlrev_b32 v14, 16, v47
    v_and_b32 v15, s86, v47
    v_pk_fma_f32 v[104:105], v[8:9], v[126:127], v[104:105] op_sel:[0,1,0] op_sel_hi:[1,1,1]
    v_pk_fma_f32 v[106:107], v[10:11], v[126:127], v[106:107] op_sel:[0,1,0] op_sel_hi:[1,1,1]
    v_pk_fma_f32 v[108:109], v[12:13], v[126:127], v[108:109] op_sel:[0,1,0] op_sel_hi:[1,1,1]
    v_pk_fma_f32 v[110:111], v[14:15], v[126:127], v[110:111] op_sel:[0,1,0] op_sel_hi:[1,1,1]
    v_lshrrev_b32 v7, 4, v1
    s_cmp_lg_u32 s3, 8
    s_cbranch_scc1 L_nocons0
    s_lshl_b32 s97, s76, 6
    s_lshl_b32 s96, s76, 10
    v_lshlrev_b32 v119, 2, v6
    buffer_load_dword v118, v119, s[64:67], s97 offen sc1
    buffer_load_dwordx4 v[96:99], v1, s[48:51], s96 offen
    buffer_load_dwordx4 v[100:103], v1, s[72:75], 0 offen
L_nocons0:
    v_mov_b32 v3, v116
    v_lshlrev_b32 v8, 5, v6
    v_lshl_add_u32 v8, v5, 3, v8
    v_max_f32_dpp v3, v3, v3 row_bcast:15 row_mask:0xa bank_mask:0xf
    s_mul_i32 s97, s3, 520
    v_add_u32 v8, s97, v8
    v_max_f32_dpp v3, v3, v3 row_bcast:31 row_mask:0xc bank_mask:0xf
    s_lshl_b32 s97, s3, 3
    v_mov_b32 v9, s97
    v_readlane_b32 s82, v3, 63
    s_nop 1
    v_subrev_f32 v2, s82, v116
    v_mul_f32 v2, s88, v2
    v_exp_f32 v2, v2
    v_mov_b32 v116, s82
    v_pk_mul_f32 v[104:105], v[104:105], v[2:3] op_sel_hi:[1,0]
    v_pk_mul_f32 v[106:107], v[106:107], v[2:3] op_sel_hi:[1,0]
    v_pk_mul_f32 v[108:109], v[108:109], v[2:3] op_sel_hi:[1,0]
    v_pk_mul_f32 v[110:111], v[110:111], v[2:3] op_sel_hi:[1,0]
    v_mul_f32 v117, v117, v2
    v_permlane32_swap_b32 v104, v108
    v_permlane32_swap_b32 v105, v109
    v_permlane32_swap_b32 v106, v110
    v_permlane32_swap_b32 v107, v111
    v_add_f32 v104, v104, v108
    v_add_f32 v105, v105, v109
    v_add_f32 v106, v106, v110
    v_add_f32 v107, v107, v111
    s_nop 0
    v_permlane16_swap_b32 v104, v106
    v_permlane16_swap_b32 v105, v107
    v_add_f32 v104, v104, v106
    v_add_f32 v105, v105, v107
    v_add_f32_dpp v117, v117, v117 row_bcast:15 row_mask:0xa bank_mask:0xf
    ds_write_b64 v8, v[104:105] offset:0
    s_nop 0
    v_add_f32_dpp v117, v117, v117 row_bcast:31 row_mask:0xc bank_mask:0xf
    s_mov_b32 exec_lo, 0
    s_mov_b32 exec_hi, 0x80000000
    ds_write_b64 v9, v[116:117] offset:12288
    s_mov_b64 exec, -1
    v_mul_u32_u24 v10, 520, v6
    v_lshl_add_u32 v10, v5, 3, v10
    s_lshl_b32 s96, s3, 5
    v_add_u32 v10, s96, v10
    v_lshlrev_b32 v11, 3, v6
    v_mul_u32_u24 v12, 136, v6
    v_add_u32 v12, s97, v12
    v_lshlrev_b32 v13, 5, v7
    s_mul_i32 s97, s3, 2064
    s_add_u32 s97, s97, 16384
    v_add_u32 v13, s97, v13
    v_lshlrev_b32 v14, 13, v5
    v_and_b32 v15, 12, v7
    v_lshl_add_u32 v14, v15, 2, v14
    v_cmp_eq_u32 vcc, 1, v6
    v_add_u32 v15, 64, v14
    s_lshl_b32 s97, s3, 15
    v_cndmask_b32 v14, v14, v15, vcc
    s_add_u32 s100, s97, s100
    s_mov_b64 s[90:91], vcc
    v_and_b32 v15, 3, v7
    v_mul_u32_u24 v15, 8256, v15
    v_lshl_add_u32 v15, v5, 5, v15
    v_and_b32 v4, 4, v7
    v_lshl_add_u32 v15, v4, 2, v15
    v_bfe_u32 v4, v7, 3, 1
    v_mul_u32_u24 v4, 33024, v4
    s_lshl_b32 s97, s3, 7
    s_add_u32 s97, s97, 16384
    v_add3_u32 v15, v15, v4, s97
    v_lshlrev_b32 v16, 16, v48
    v_and_b32 v48, s86, v48
    v_lshlrev_b32 v17, 16, v49
    v_and_b32 v49, s86, v49
    v_lshlrev_b32 v18, 16, v50
    v_and_b32 v50, s86, v50
    v_lshlrev_b32 v19, 16, v51
    v_and_b32 v51, s86, v51
    v_lshlrev_b32 v20, 16, v52
    v_and_b32 v52, s86, v52
    v_lshlrev_b32 v21, 16, v53
    v_and_b32 v53, s86, v53
    v_lshlrev_b32 v22, 16, v54
    v_and_b32 v54, s86, v54
    v_lshlrev_b32 v23, 16, v55
    v_and_b32 v55, s86, v55
    v_lshlrev_b32 v24, 16, v56
    v_and_b32 v56, s86, v56
    v_lshlrev_b32 v25, 16, v57
    v_and_b32 v57, s86, v57
    v_lshlrev_b32 v26, 16, v58
    v_and_b32 v58, s86, v58
    v_lshlrev_b32 v27, 16, v59
    v_and_b32 v59, s86, v59
    v_lshlrev_b32 v28, 16, v60
    v_and_b32 v60, s86, v60
    v_lshlrev_b32 v29, 16, v61
    v_and_b32 v61, s86, v61
    v_lshlrev_b32 v30, 16, v62
    v_and_b32 v62, s86, v62
    v_lshlrev_b32 v31, 16, v63
    v_and_b32 v63, s86, v63
    v_lshlrev_b32 v32, 16, v64
    v_and_b32 v64, s86, v64
    v_lshlrev_b32 v33, 16, v65
    v_and_b32 v65, s86, v65
    v_lshlrev_b32 v34, 16, v66
    v_and_b32 v66, s86, v66
    v_lshlrev_b32 v35, 16, v67
    v_and_b32 v67, s86, v67
    v_lshlrev_b32 v36, 16, v68
    v_and_b32 v68, s86, v68
    v_lshlrev_b32 v37, 16, v69
    v_and_b32 v69, s86, v69
    v_lshlrev_b32 v38, 16, v70
    v_and_b32 v70, s86, v70
    v_lshlrev_b32 v39, 16, v71
    v_and_b32 v71, s86, v71
    v_lshlrev_b32 v40, 16, v72
    v_and_b32 v72, s86, v72
    v_lshlrev_b32 v41, 16, v73
    v_and_b32 v73, s86, v73
    v_lshlrev_b32 v42, 16, v74
    v_and_b32 v74, s86, v74
    v_lshlrev_b32 v43, 16, v75
    v_and_b32 v75, s86, v75
    v_lshlrev_b32 v44, 16, v76
    v_and_b32 v76, s86, v76
    v_lshlrev_b32 v45, 16, v77
    v_and_b32 v77, s86, v77
    v_lshlrev_b32 v46, 16, v78
    v_and_b32 v78, s86, v78
    v_lshlrev_b32 v47, 16, v79
    v_and_b32 v79, s86, v79
    s_waitcnt lgkmcnt(0)
    s_barrier
    ds_read_b64 v[120:121], v11 offset:12288
    ds_read_b64 v[122:123], v10 offset:0
    ds_read_b64 v[104:105], v12 offset:8448
    v_mov_b32 v106, 0xbfb8aa3b
    s_waitcnt lgkmcnt(2)
    v_mov_b32 v3, v120
    s_nop 1
    v_max_f32_dpp v3, v3, v3 row_ror:8 row_mask:0xf bank_mask:0xf
    s_nop 1
    v_max_f32_dpp v3, v3, v3 row_ror:4 row_mask:0xf bank_mask:0xf
    s_nop 1
    v_max_f32_dpp v3, v3, v3 row_ror:2 row_mask:0xf bank_mask:0xf
    s_nop 1
    v_max_f32_dpp v3, v3, v3 row_ror:1 row_mask:0xf bank_mask:0xf
    v_sub_f32 v2, v120, v3
    v_mul_f32 v2, s88, v2
    v_exp_f32 v2, v2
    s_waitcnt lgkmcnt(0)
    v_add_f32_dpp v104, v104, v104 quad_perm:[1,0,3,2] row_mask:0xf bank_mask:0xf
    v_add_f32_dpp v105, v105, v105 quad_perm:[1,0,3,2] row_mask:0xf bank_mask:0xf
    v_mul_f32 v121, v121, v2
    v_mul_f32 v122, v122, v2
    v_mul_f32 v123, v123, v2
    v_add_f32_dpp v104, v104, v104 quad_perm:[2,3,0,1] row_mask:0xf bank_mask:0xf
    v_add_f32_dpp v105, v105, v105 quad_perm:[2,3,0,1] row_mask:0xf bank_mask:0xf
    v_add_f32_dpp v121, v121, v121 row_ror:8 row_mask:0xf bank_mask:0xf
    v_add_f32_dpp v122, v122, v122 row_ror:8 row_mask:0xf bank_mask:0xf
    v_add_f32_dpp v123, v123, v123 row_ror:8 row_mask:0xf bank_mask:0xf
    v_add_f32_dpp v104, v104, v104 row_half_mirror row_mask:0xf bank_mask:0xf
    v_add_f32_dpp v105, v105, v105 row_half_mirror row_mask:0xf bank_mask:0xf
    v_add_f32_dpp v121, v121, v121 row_ror:4 row_mask:0xf bank_mask:0xf
    v_add_f32_dpp v122, v122, v122 row_ror:4 row_mask:0xf bank_mask:0xf
    v_add_f32_dpp v123, v123, v123 row_ror:4 row_mask:0xf bank_mask:0xf
    v_add_f32_dpp v121, v121, v121 row_ror:2 row_mask:0xf bank_mask:0xf
    v_add_f32_dpp v122, v122, v122 row_ror:2 row_mask:0xf bank_mask:0xf
    v_add_f32_dpp v123, v123, v123 row_ror:2 row_mask:0xf bank_mask:0xf
    v_add_f32_dpp v121, v121, v121 row_ror:1 row_mask:0xf bank_mask:0xf
    v_add_f32_dpp v122, v122, v122 row_ror:1 row_mask:0xf bank_mask:0xf
    v_add_f32_dpp v123, v123, v123 row_ror:1 row_mask:0xf bank_mask:0xf
    v_rcp_f32 v2, v121
    v_log_f32 v4, v121
    v_readlane_b32 s82, v104, 0
    v_readlane_b32 s83, v105, 0
    v_mul_f32 v122, v122, v2
    v_mul_f32 v123, v123, v2
    v_readlane_b32 s84, v104, 8
    v_readlane_b32 s85, v105, 8
    v_fma_f32 v4, v3, s88, v4
    v_mul_f32 v104, s82, v106
    v_mul_f32 v105, s83, v106
    v_readlane_b32 s4, v122, 0
    v_readlane_b32 s5, v123, 0
    v_readlane_b32 s6, v122, 16
    v_readlane_b32 s7, v123, 16
    v_readlane_b32 s8, v122, 32
    v_readlane_b32 s9, v123, 32
    v_readlane_b32 s10, v122, 48
    v_readlane_b32 s11, v123, 48
    v_exp_f32 v104, v104
    v_exp_f32 v105, v105
    v_pk_mul_f32 v[120:121], v[16:17], s[4:5] op_sel_hi:[1,0]
    v_pk_mul_f32 v[122:123], v[18:19], s[4:5] op_sel_hi:[1,0]
    v_pk_mul_f32 v[124:125], v[48:49], s[4:5] op_sel_hi:[1,0]
    v_pk_mul_f32 v[126:127], v[50:51], s[4:5] op_sel_hi:[1,0]
    v_add_f32 v104, 1.0, v104
    v_add_f32 v105, 1.0, v105
    v_pk_fma_f32 v[120:121], v[20:21], s[4:5], v[120:121] op_sel:[0,1,0] op_sel_hi:[1,1,1]
    v_pk_fma_f32 v[122:123], v[22:23], s[4:5], v[122:123] op_sel:[0,1,0] op_sel_hi:[1,1,1]
    v_pk_fma_f32 v[124:125], v[52:53], s[4:5], v[124:125] op_sel:[0,1,0] op_sel_hi:[1,1,1]
    v_pk_fma_f32 v[126:127], v[54:55], s[4:5], v[126:127] op_sel:[0,1,0] op_sel_hi:[1,1,1]
    v_rcp_f32 v104, v104
    v_rcp_f32 v105, v105
    v_pk_fma_f32 v[120:121], v[24:25], s[6:7], v[120:121] op_sel_hi:[1,0,1]
    v_pk_fma_f32 v[122:123], v[26:27], s[6:7], v[122:123] op_sel_hi:[1,0,1]
    v_pk_fma_f32 v[124:125], v[56:57], s[6:7], v[124:125] op_sel_hi:[1,0,1]
    v_pk_fma_f32 v[126:127], v[58:59], s[6:7], v[126:127] op_sel_hi:[1,0,1]
    v_mul_f32 v104, s82, v104
    v_mul_f32 v105, s83, v105
    v_pk_fma_f32 v[120:121], v[28:29], s[6:7], v[120:121] op_sel:[0,1,0] op_sel_hi:[1,1,1]
    v_pk_fma_f32 v[122:123], v[30:31], s[6:7], v[122:123] op_sel:[0,1,0] op_sel_hi:[1,1,1]
    v_pk_fma_f32 v[124:125], v[60:61], s[6:7], v[124:125] op_sel:[0,1,0] op_sel_hi:[1,1,1]
    v_pk_fma_f32 v[126:127], v[62:63], s[6:7], v[126:127] op_sel:[0,1,0] op_sel_hi:[1,1,1]
    v_mul_f32 v104, s84, v104
    v_mul_f32 v105, s85, v105
    v_pk_fma_f32 v[120:121], v[32:33], s[8:9], v[120:121] op_sel_hi:[1,0,1]
    v_pk_fma_f32 v[122:123], v[34:35], s[8:9], v[122:123] op_sel_hi:[1,0,1]
    v_pk_fma_f32 v[124:125], v[64:65], s[8:9], v[124:125] op_sel_hi:[1,0,1]
    v_pk_fma_f32 v[126:127], v[66:67], s[8:9], v[126:127] op_sel_hi:[1,0,1]
    v_mul_f32 v104, s92, v104
    v_mul_f32 v105, s92, v105
    v_pk_fma_f32 v[120:121], v[36:37], s[8:9], v[120:121] op_sel:[0,1,0] op_sel_hi:[1,1,1]
    v_pk_fma_f32 v[122:123], v[38:39], s[8:9], v[122:123] op_sel:[0,1,0] op_sel_hi:[1,1,1]
    v_pk_fma_f32 v[124:125], v[68:69], s[8:9], v[124:125] op_sel:[0,1,0] op_sel_hi:[1,1,1]
    v_pk_fma_f32 v[126:127], v[70:71], s[8:9], v[126:127] op_sel:[0,1,0] op_sel_hi:[1,1,1]
    v_pk_fma_f32 v[120:121], v[40:41], s[10:11], v[120:121] op_sel_hi:[1,0,1]
    v_pk_fma_f32 v[122:123], v[42:43], s[10:11], v[122:123] op_sel_hi:[1,0,1]
    v_pk_fma_f32 v[124:125], v[72:73], s[10:11], v[124:125] op_sel_hi:[1,0,1]
    v_pk_fma_f32 v[126:127], v[74:75], s[10:11], v[126:127] op_sel_hi:[1,0,1]
    v_pk_fma_f32 v[120:121], v[44:45], s[10:11], v[120:121] op_sel:[0,1,0] op_sel_hi:[1,1,1]
    v_pk_fma_f32 v[122:123], v[46:47], s[10:11], v[122:123] op_sel:[0,1,0] op_sel_hi:[1,1,1]
    v_pk_fma_f32 v[124:125], v[76:77], s[10:11], v[124:125] op_sel:[0,1,0] op_sel_hi:[1,1,1]
    v_pk_fma_f32 v[126:127], v[78:79], s[10:11], v[126:127] op_sel:[0,1,0] op_sel_hi:[1,1,1]
    v_mov_b32 v16, v120
    v_mov_b32 v17, v124
    v_mov_b32 v18, v121
    v_mov_b32 v19, v125
    v_mov_b32 v20, v122
    v_mov_b32 v21, v126
    v_mov_b32 v22, v123
    v_mov_b32 v23, v127
    ds_write_b128 v13, v[16:19]
    ds_write_b128 v13, v[20:23] offset:16
    v_pk_mul_f32 v[80:81], v[80:81], v[104:105] op_sel_hi:[1,0]
    v_pk_mul_f32 v[82:83], v[82:83], v[104:105] op_sel_hi:[1,0]
    v_pk_mul_f32 v[84:85], v[84:85], v[104:105] op_sel_hi:[1,0]
    v_pk_mul_f32 v[86:87], v[86:87], v[104:105] op_sel_hi:[1,0]
    v_pk_fma_f32 v[80:81], v[88:89], v[104:105], v[80:81] op_sel:[0,1,0] op_sel_hi:[1,1,1]
    v_pk_fma_f32 v[82:83], v[90:91], v[104:105], v[82:83] op_sel:[0,1,0] op_sel_hi:[1,1,1]
    v_pk_fma_f32 v[84:85], v[92:93], v[104:105], v[84:85] op_sel:[0,1,0] op_sel_hi:[1,1,1]
    v_pk_fma_f32 v[86:87], v[94:95], v[104:105], v[86:87] op_sel:[0,1,0] op_sel_hi:[1,1,1]
    ds_write_b128 v13, v[80:83] offset:33024
    ds_write_b128 v13, v[84:87] offset:33040
    s_waitcnt lgkmcnt(0)
    s_barrier
    ds_read_b128 v[32:35], v15 offset:0
    ds_read_b128 v[36:39], v15 offset:2064
    ds_read_b128 v[40:43], v15 offset:4128
    ds_read_b128 v[44:47], v15 offset:6192
    s_waitcnt lgkmcnt(2)
    v_pk_add_f32 v[32:33], v[32:33], v[36:37]
    v_pk_add_f32 v[34:35], v[34:35], v[38:39]
    s_waitcnt lgkmcnt(0)
    v_pk_add_f32 v[40:41], v[40:41], v[44:45]
    v_pk_add_f32 v[42:43], v[42:43], v[46:47]
    v_pk_add_f32 v[32:33], v[32:33], v[40:41]
    v_pk_add_f32 v[34:35], v[34:35], v[42:43]
    s_nop 0
    v_add_f32_dpp v32, v32, v32 quad_perm:[1,0,3,2] row_mask:0xf bank_mask:0xf
    v_add_f32_dpp v33, v33, v33 quad_perm:[1,0,3,2] row_mask:0xf bank_mask:0xf
    v_add_f32_dpp v34, v34, v34 quad_perm:[1,0,3,2] row_mask:0xf bank_mask:0xf
    v_add_f32_dpp v35, v35, v35 quad_perm:[1,0,3,2] row_mask:0xf bank_mask:0xf
    v_add_f32_dpp v32, v32, v32 quad_perm:[2,3,0,1] row_mask:0xf bank_mask:0xf
    v_add_f32_dpp v33, v33, v33 quad_perm:[2,3,0,1] row_mask:0xf bank_mask:0xf
    v_add_f32_dpp v34, v34, v34 quad_perm:[2,3,0,1] row_mask:0xf bank_mask:0xf
    v_add_f32_dpp v35, v35, v35 quad_perm:[2,3,0,1] row_mask:0xf bank_mask:0xf
    v_cndmask_b32 v32, v32, v4, s[90:91]
    s_mov_b32 exec_lo, 0x11131113
    s_mov_b32 exec_hi, 0x11131113
    buffer_store_dwordx4 v[32:35], v14, s[60:63], s100 offen sc1
    s_mov_b64 exec, -1
    s_cmp_lg_u32 s3, 8
    s_cbranch_scc1 L_end
    s_waitcnt vmcnt(1)
    v_dot2_f32_bf16 v10, v96, v100, 0
    v_dot2_f32_bf16 v10, v97, v101, v10
    v_dot2_f32_bf16 v10, v98, v102, v10
    v_dot2_f32_bf16 v10, v99, v103, v10
    s_lshl_b32 s96, s76, 6
    s_add_u32 s96, s96, s93
    s_lshl_b32 s96, s96, 13
    v_lshlrev_b32 v8, 7, v7
    s_lshl_b32 s97, s76, 6
    s_mov_b32 s80, 0x8000
L_cnt:
    v_cmp_ne_u32 vcc, 0x01010101, v118
    s_nop 0
    s_cmp_eq_u64 vcc, 0
    s_cbranch_scc1 L_poll
    buffer_load_dword v118, v119, s[64:67], s97 offen sc1
    s_sub_u32 s80, s80, 1
    s_cmp_eq_u32 s80, 0
    s_waitcnt vmcnt(0)
    s_cbranch_scc0 L_cnt
    s_mov_b32 s80, 1
L_poll:
    buffer_load_dwordx4 v[16:19], v8, s[60:63], s96 offen sc1
    buffer_load_dwordx4 v[20:23], v8, s[60:63], s96 offen offset:16 sc1
    buffer_load_dword v48, v8, s[60:63], s96 offen offset:64 sc1
    buffer_load_dwordx4 v[24:27], v8, s[60:63], s96 offen offset:32 sc1
    buffer_load_dwordx4 v[28:31], v8, s[60:63], s96 offen offset:48 sc1
    s_sub_u32 s80, s80, 1
    s_waitcnt vmcnt(0)
    v_pk_add_f32 v[50:51], v[16:17], v[18:19]
    v_pk_add_f32 v[52:53], v[20:21], v[22:23]
    v_pk_add_f32 v[54:55], v[24:25], v[26:27]
    v_pk_add_f32 v[56:57], v[28:29], v[30:31]
    v_pk_add_f32 v[50:51], v[50:51], v[52:53]
    v_pk_add_f32 v[54:55], v[54:55], v[56:57]
    v_pk_add_f32 v[50:51], v[50:51], v[54:55]
    v_add_f32 v50, v50, v51
    v_add_f32 v50, v50, v48
    v_cmp_u_f32 vcc, v50, v50
    s_cmp_eq_u32 s80, 0
    s_cbranch_scc1 L_done
    s_and_b64 exec, vcc, vcc
    s_cbranch_scc1 L_poll
L_done:
    s_mov_b64 exec, -1
    s_nop 4
    v_add_f32_dpp v10, v10, v10 row_ror:8 row_mask:0xf bank_mask:0xf
    s_nop 1
    v_add_f32_dpp v10, v10, v10 row_ror:4 row_mask:0xf bank_mask:0xf
    s_nop 1
    v_add_f32_dpp v10, v10, v10 row_ror:2 row_mask:0xf bank_mask:0xf
    s_nop 1
    v_add_f32_dpp v10, v10, v10 row_ror:1 row_mask:0xf bank_mask:0xf
    s_nop 1
    v_add_f32_dpp v10, v10, v10 row_bcast:15 row_mask:0xa bank_mask:0xf
    s_nop 1
    v_add_f32_dpp v10, v10, v10 row_bcast:31 row_mask:0xc bank_mask:0xf
    v_sub_f32_dpp v49, v48, v48 quad_perm:[1,0,3,2] row_mask:0xf bank_mask:0xf
    v_readlane_b32 s82, v10, 63
    v_exp_f32 v49, v49
    v_mov_b32 v12, 0xbfb8aa3b
    v_mul_f32 v10, s82, v12
    v_add_f32 v49, 1.0, v49
    v_exp_f32 v10, v10
    v_rcp_f32 v49, v49
    v_add_f32 v10, 1.0, v10
    v_rcp_f32 v10, v10
    s_nop 0
    v_mul_f32 v50, v49, v10
    v_sub_f32 v51, 1.0, v10
    v_pk_mul_f32 v[16:17], v[16:17], v[50:51] op_sel_hi:[1,0]
    v_pk_mul_f32 v[18:19], v[18:19], v[50:51] op_sel_hi:[1,0]
    v_pk_mul_f32 v[20:21], v[20:21], v[50:51] op_sel_hi:[1,0]
    v_pk_mul_f32 v[22:23], v[22:23], v[50:51] op_sel_hi:[1,0]
    v_pk_fma_f32 v[16:17], v[24:25], v[50:51], v[16:17] op_sel:[0,1,0] op_sel_hi:[1,1,1]
    v_pk_fma_f32 v[18:19], v[26:27], v[50:51], v[18:19] op_sel:[0,1,0] op_sel_hi:[1,1,1]
    v_pk_fma_f32 v[20:21], v[28:29], v[50:51], v[20:21] op_sel:[0,1,0] op_sel_hi:[1,1,1]
    v_pk_fma_f32 v[22:23], v[30:31], v[50:51], v[22:23] op_sel:[0,1,0] op_sel_hi:[1,1,1]
    s_nop 0
    v_permlane32_swap_b32 v16, v20
    v_permlane32_swap_b32 v17, v21
    v_permlane32_swap_b32 v18, v22
    v_permlane32_swap_b32 v19, v23
    v_add_f32 v16, v16, v20
    v_add_f32 v17, v17, v21
    v_add_f32 v18, v18, v22
    v_add_f32 v19, v19, v23
    s_nop 0
    v_permlane16_swap_b32 v16, v18
    v_permlane16_swap_b32 v17, v19
    v_add_f32 v16, v16, v18
    v_add_f32 v17, v17, v19
    s_nop 0
    v_add_f32_dpp v16, v16, v16 row_ror:8 row_mask:0xf bank_mask:0xf
    v_add_f32_dpp v17, v17, v17 row_ror:8 row_mask:0xf bank_mask:0xf
    s_nop 0
    v_add_f32_dpp v16, v16, v16 row_ror:4 row_mask:0xf bank_mask:0xf
    v_add_f32_dpp v17, v17, v17 row_ror:4 row_mask:0xf bank_mask:0xf
    s_nop 0
    v_add_f32_dpp v16, v16, v16 row_ror:2 row_mask:0xf bank_mask:0xf
    v_add_f32_dpp v17, v17, v17 row_ror:2 row_mask:0xf bank_mask:0xf
    s_nop 0
    v_add_f32_dpp v16, v16, v16 row_ror:1 row_mask:0xf bank_mask:0xf
    v_add_f32_dpp v17, v17, v17 row_ror:1 row_mask:0xf bank_mask:0xf
    v_cvt_pk_bf16_f32 v16, v16, v17
    s_lshl_b32 s96, s76, 10
    s_lshl_b32 s95, s93, 4
    s_add_u32 s96, s96, s95
    v_lshlrev_b32 v8, 2, v5
    s_mov_b32 exec_lo, 0x00010001
    s_mov_b32 exec_hi, 0x00010001
    buffer_store_dword v16, v8, s[68:71], s96 offen
L_end:
    s_endpgm
.section .rodata,"a"
.p2align 6
.amdhsa_kernel gated_mix__mha_block_cached__glu_gated_swiglu__decode_kernel
  .amdhsa_next_free_vgpr 128
  .amdhsa_next_free_sgpr 102
  .amdhsa_accum_offset 128
  .amdhsa_group_segment_fixed_size 0
  .amdhsa_kernarg_size 104
  .amdhsa_user_sgpr_count 2
  .amdhsa_user_sgpr_kernarg_segment_ptr 1
  .amdhsa_system_sgpr_workgroup_id_x 1
.end_amdhsa_kernel
```
